```python
import torch

def _softmax(x, axis=-1):
    return torch.softmax(x, dim=axis)
def _gelu(x):
    return torch.nn.functional.gelu(x, approximate="tanh")
def _silu(x):
    return torch.nn.functional.silu(x)
def _sigmoid(x):
    return torch.sigmoid(x)
def _layernorm(x, axis=-1, eps=1e-5):
    m = x.mean(dim=axis, keepdim=True)
    v = x.var(dim=axis, keepdim=True, unbiased=False)
    return (x - m) / torch.sqrt(v + eps)
def _scatter_add(tgt, idx, src, axis=0):
    return tgt.clone().index_add_(axis, idx, src)
def _segment_sum(src, seg, n):
    out = torch.zeros((n,) + src.shape[1:], dtype=src.dtype)
    return out.index_add_(0, seg, src)
def _pad(x, pw):
    flat = tuple(v for pair in reversed(pw) for v in pair)
    return torch.nn.functional.pad(x, flat)

kernel_name = 'gated_mix__sliding_block__swiglu_ffn__prompt'

def setup_inputs():

    _w = (lambda a: (lambda t: t.to(torch.bfloat16) if t.is_floating_point() else t)(torch.as_tensor(a)))
    def _A_setup():
        B, S, D = 1, 2048, 640
        return {
            "x": _w((lambda *s: torch.randn(*s, dtype=torch.bfloat16) * 0.05)(B, S, D)),
            "wqkv": _w((lambda *s: torch.randn(*s, dtype=torch.bfloat16) * 0.8)(D, 3 * D)),
            "wo": _w((lambda *s: torch.randn(*s, dtype=torch.bfloat16) * 0.05)(D, D)),
        }
    _A_in = _A_setup()

    def _B_setup():
        B, S, D, F = 1, 2048, 640, 1536
        return {
            "x": _w((lambda *s: torch.randn(*s, dtype=torch.bfloat16) * 0.05)(B, S, D)),
            "w_gate": _w((lambda *s: torch.randn(*s, dtype=torch.bfloat16) * 0.2)(D, F)),
            "w_up": _w((lambda *s: torch.randn(*s, dtype=torch.bfloat16) * 0.2)(D, F)),
            "w_down": _w((lambda *s: torch.randn(*s, dtype=torch.bfloat16) * 0.2)(F, D)),
        }
    _B_in = _B_setup()

    return {
        "A_x": _A_in["x"],
        "A_wqkv": _A_in["wqkv"],
        "A_wo": _A_in["wo"],
        "B_x": _B_in["x"],
        "B_w_gate": _B_in["w_gate"],
        "B_w_up": _B_in["w_up"],
        "B_w_down": _B_in["w_down"],
        "gate_w": _w((lambda *s: torch.randn(*s, dtype=torch.bfloat16) * 0.05)(640) * 16.0),
    }

def reference(A_x, A_wqkv, A_wo, B_x, B_w_gate, B_w_up, B_w_down, gate_w):
    def _A_ref(x, wqkv, wo):
        B, S, D = x.shape
        H = 32; Dh = D // H; W = 256
        qkv = (lambda x, *d: x.permute(*d))((x @ wqkv).reshape(B, S, 3, H, Dh), 2, 0, 3, 1, 4)
        q, k, v = qkv[0], qkv[1], qkv[2]
        scores = torch.einsum("bhqd,bhkd->bhqk", q, k) * (Dh ** -0.5)
        idx = torch.arange(S)
        mask = (idx[:, None] - idx[None, :] >= 0) & (idx[:, None] - idx[None, :] < W)
        scores = torch.where(mask[None, None], scores, -1e9)
        p = _softmax(scores, axis=-1)
        o = torch.einsum("bhqk,bhkd->bhqd", p, v)
        return (lambda x, *d: x.permute(*d))(o, 0, 2, 1, 3).reshape(B, S, D) @ wo

    def _B_ref(x, w_gate, w_up, w_down):
        g = _silu(x @ w_gate)
        u = x @ w_up
        return (g * u) @ w_down

    x = A_x
    g = _sigmoid((x * gate_w).sum(-1, keepdims=True))
    a = _A_ref(x, A_wqkv, A_wo)
    b = _B_ref(x, B_w_gate, B_w_up, B_w_down)
    return g * a + (1 - g) * b
```

```asm
; @launch grid=(256,1,1) block=(512,1,1) lds=163840
.amdgcn_target "amdgcn-amd-amdhsa--gfx950"
.text
.globl gated_mix__sliding_block__swiglu_ffn__prompt_kernel
.p2align 8
.type gated_mix__sliding_block__swiglu_ffn__prompt_kernel,@function
gated_mix__sliding_block__swiglu_ffn__prompt_kernel:
    s_cmp_ge_u32 s2, 256
    s_cbranch_scc1 END
    s_load_dwordx4 s[40:43], s[0:1], 0
    s_load_dwordx2 s[44:45], s[0:1], 16
    s_load_dwordx8 s[48:55], s[0:1], 32
    s_load_dwordx4 s[56:59], s[0:1], 64
    s_load_dwordx2 s[12:13], s[0:1], 80
    v_lshrrev_b32 v1, 6, v0
    v_and_b32 v0, 63, v0
    v_readfirstlane_b32 s30, v1
    s_and_b32 s24, s2, 7
    s_lshr_b32 s25, s2, 3
    s_and_b32 s26, s24, 1
    s_lshl_b32 s26, s26, 3
    s_and_b32 s27, s25, 7
    s_add_u32 s26, s26, s27
    s_lshr_b32 s27, s24, 1
    s_lshl_b32 s27, s27, 2
    s_lshr_b32 s28, s25, 3
    s_add_u32 s27, s27, s28
    s_lshr_b32 s31, s30, 1
    s_and_b32 s32, s30, 1
    s_lshr_b32 s33, s30, 2
    s_and_b32 s34, s30, 3
    v_and_b32 v13, 15, v0
    v_lshrrev_b32 v14, 4, v0
    s_lshl_b32 s35, s26, 7
    s_lshl_b32 s36, s31, 5
    s_add_u32 s35, s35, s36
    s_add_u32 s35, s35, s32
    v_lshrrev_b32 v16, 3, v0
    v_lshl_add_u32 v16, v16, 1, s35
    v_mul_u32_u24 v16, 1280, v16
    v_and_b32 v17, 7, v0
    v_xor_b32 v17, v17, v14
    v_lshl_add_u32 v1, v17, 4, v16
    v_xor_b32 v17, 4, v17
    v_lshl_add_u32 v2, v17, 4, v16
    v_add_u32 v2, 20480, v2
    s_lshl_b32 s35, s33, 5
    s_and_b32 s36, s31, 1
    s_lshl_b32 s36, s36, 2
    s_add_u32 s35, s35, s36
    s_lshl_b32 s36, s32, 4
    s_add_u32 s35, s35, s36
    v_add_u32 v18, s35, v14
    v_mul_u32_u24 v16, 3840, v18
    s_lshl_b32 s36, s27, 8
    v_add_u32 v16, s36, v16
    v_lshlrev_b32 v17, 1, v14
    v_xor_b32 v17, v17, v13
    v_lshl_add_u32 v3, v17, 4, v16
    v_xor_b32 v17, 8, v17
    v_lshl_add_u32 v4, v17, 4, v16
    v_add_u32 v4, 30720, v4
    s_lshl_b32 s60, s30, 11
    s_lshl_b32 s61, s30, 10
    s_and_b32 s35, s25, 7
    s_lshl_b32 s36, s28, 1
    s_and_b32 s36, s24, 6
    s_add_u32 s35, s35, s36
    s_and_b32 s36, s24, 0
    s_lshl_b32 s36, s36, 2
    s_add_u32 s35, s35, s36
    s_mul_i32 s35, s35, 5
    s_mul_i32 s36, s24, 0
    s_add_u32 s35, s35, s36
    s_lshr_b32 s35, s35, 2
    s_cmp_ge_u32 s35, 10
    s_cselect_b32 s36, 10, 0
    s_sub_u32 s35, s35, s36
    s_and_b32 s35, s35, 15
    s_lshl_b32 s62, s35, 7
    s_mul_i32 s63, s35, 245760
    s_mul_i32 s64, s35, 196608
    s_mov_b32 s6, 2621440
    s_mov_b32 s7, 0x20000
    s_mov_b32 s10, 2457600
    s_mov_b32 s65, 245760
    s_mov_b32 s11, 0x20000
    s_mov_b32 s14, 0x10000000
    s_mov_b32 s15, 0x20000
    s_waitcnt lgkmcnt(0)
    s_mov_b32 s4, s40
    s_mov_b32 s5, s41
    s_mov_b32 s8, s42
    s_mov_b32 s9, s43
    s_cmp_lg_u32 s27, 15
    s_cbranch_scc1 NOTG
    s_mov_b32 s8, s54
    s_mov_b32 s9, s55
    s_mov_b32 s10, 1280
    s_mov_b32 s63, s62
    s_mov_b32 s65, 128
    v_and_b32 v19, 1, v14
    v_and_b32 v18, 0xfe, v18
    v_lshlrev_b32 v18, 1, v18
    v_add_u32 v20, 16, v18
    v_mov_b32 v21, 0x7ff00000
    v_cmp_eq_u32 vcc, v17, v19
    s_nop 1
    v_cndmask_b32 v4, v21, v20, vcc
    v_xor_b32 v17, 8, v17
    v_cmp_eq_u32 vcc, v17, v19
    s_nop 1
    v_cndmask_b32 v3, v21, v18, vcc
NOTG:
    s_add_u32 m0, s60, 0
    s_nop 0
    buffer_load_dwordx4 v1, s[4:7], s62 offen lds
    s_add_u32 m0, m0, 1024
    s_nop 0
    buffer_load_dwordx4 v2, s[4:7], s62 offen lds
    s_add_u32 m0, m0, 15360
    s_add_u32 s62, s62, 128
    buffer_load_dwordx4 v3, s[8:11], s63 offen lds
    s_add_u32 m0, m0, 1024
    s_nop 0
    buffer_load_dwordx4 v4, s[8:11], s63 offen lds
    s_add_u32 s63, s63, s65
    s_cmp_eq_u32 s62, 1280
    s_cselect_b32 s62, 0, s62
    s_cselect_b32 s63, 0, s63
    s_cmp_eq_u32 s33, 0
    s_cselect_b32 s16, s48, s50
    s_cselect_b32 s17, s49, s51
    s_mov_b32 s18, 1966080
    s_mov_b32 s19, 0x20000
    v_lshrrev_b32 v16, 1, v13
    v_xor_b32 v16, v16, v14
    v_lshlrev_b32 v16, 4, v16
    v_lshl_add_u32 v16, v13, 7, v16
    s_lshl_b32 s35, s31, 12
    v_add_u32 v5, s35, v16
    v_xor_b32 v6, 64, v5
    v_lshrrev_b32 v16, 2, v0
    v_and_b32 v17, 7, v16
    v_lshlrev_b32 v17, 5, v17
    v_lshl_add_u32 v17, v16, 8, v17
    v_and_b32 v18, 3, v0
    v_lshl_add_u32 v17, v18, 3, v17
    s_lshl_b32 s35, s32, 7
    v_xor_b32 v7, s35, v17
    v_xor_b32 v8, 32, v7
    v_xor_b32 v9, 64, v7
    v_xor_b32 v10, 0x60, v7
    s_barrier
    s_add_u32 m0, s60, 32768
    s_nop 0
    buffer_load_dwordx4 v1, s[4:7], s62 offen lds
    s_add_u32 m0, m0, 1024
    s_nop 0
    buffer_load_dwordx4 v2, s[4:7], s62 offen lds
    s_add_u32 m0, m0, 15360
    s_add_u32 s62, s62, 128
    buffer_load_dwordx4 v3, s[8:11], s63 offen lds
    s_add_u32 m0, m0, 1024
    s_nop 0
    buffer_load_dwordx4 v4, s[8:11], s63 offen lds
    s_add_u32 s63, s63, s65
    s_cmp_eq_u32 s62, 1280
    s_cselect_b32 s62, 0, s62
    s_cselect_b32 s63, 0, s63
    s_mov_b32 s48, s58
    s_mov_b32 s49, s59
    s_mov_b32 s50, 256
    s_mov_b32 s51, 0x20000
    s_sub_u32 s100, 15, s27
    s_lshl_b32 s100, s100, 3
    s_add_u32 s100, s100, s30
    s_cmp_eq_u32 s30, 0
    s_cbranch_scc1 PG0
    s_cmp_eq_u32 s30, 1
    s_cbranch_scc1 PG1
    s_cmp_eq_u32 s30, 2
    s_cbranch_scc1 PG2
    s_cmp_eq_u32 s30, 3
    s_cbranch_scc1 PG3
    s_cmp_eq_u32 s30, 4
    s_cbranch_scc1 PG4
    s_cmp_eq_u32 s30, 5
    s_cbranch_scc1 PG5
    s_cmp_eq_u32 s30, 6
    s_cbranch_scc1 PG6
    s_cmp_eq_u32 s30, 7
    s_cbranch_scc1 PG7
WARMED:
    s_add_u32 m0, s60, 65536
    s_nop 0
    buffer_load_dwordx4 v1, s[4:7], s62 offen lds
    s_add_u32 m0, m0, 1024
    s_nop 0
    buffer_load_dwordx4 v2, s[4:7], s62 offen lds
    s_add_u32 m0, m0, 15360
    s_add_u32 s62, s62, 128
    buffer_load_dwordx4 v3, s[8:11], s63 offen lds
    s_add_u32 m0, m0, 1024
    s_nop 0
    buffer_load_dwordx4 v4, s[8:11], s63 offen lds
    s_add_u32 s63, s63, s65
    s_cmp_eq_u32 s62, 1280
    s_cselect_b32 s62, 0, s62
    s_cselect_b32 s63, 0, s63
    s_waitcnt vmcnt(8)
    s_barrier
    ds_read_b128 v[96:99], v5 offset:0
    ds_read_b128 v[100:103], v5 offset:2048
    ds_read_b64_tr_b16 v[16:17], v7 offset:16384
    ds_read_b64_tr_b16 v[18:19], v7 offset:20480
    s_add_u32 m0, s60, 98304
    s_nop 0
    buffer_load_dwordx4 v1, s[4:7], s62 offen lds
    ds_read_b64_tr_b16 v[20:21], v8 offset:16384
    ds_read_b64_tr_b16 v[22:23], v8 offset:20480
    s_add_u32 m0, m0, 1024
    s_nop 0
    buffer_load_dwordx4 v2, s[4:7], s62 offen lds
    ds_read_b64_tr_b16 v[24:25], v9 offset:16384
    ds_read_b64_tr_b16 v[26:27], v9 offset:20480
    s_add_u32 m0, m0, 15360
    s_add_u32 s62, s62, 128
    buffer_load_dwordx4 v3, s[8:11], s63 offen lds
    ds_read_b64_tr_b16 v[28:29], v10 offset:16384
    ds_read_b64_tr_b16 v[30:31], v10 offset:20480
    s_add_u32 m0, m0, 1024
    s_nop 0
    buffer_load_dwordx4 v4, s[8:11], s63 offen lds
    s_add_u32 s63, s63, s65
    s_cmp_eq_u32 s62, 1280
    s_cselect_b32 s62, 0, s62
    s_cselect_b32 s63, 0, s63
    ds_read_b128 v[104:107], v6 offset:0
    ds_read_b128 v[108:111], v6 offset:2048
    ds_read_b64_tr_b16 v[32:33], v7 offset:24576
    ds_read_b64_tr_b16 v[34:35], v7 offset:28672
    s_cmp_gt_u32 s100, 3
    s_cbranch_scc1 NORST
    v_mov_b32 v80, 0
    v_mov_b32 v81, 0
    v_mov_b32 v82, 0
    v_mov_b32 v83, 0
    v_lshlrev_b32 v84, 4, v0
    s_lshl_b32 s101, s26, 2
    s_add_u32 s101, s101, s30
    s_lshl_b32 s101, s101, 10
    s_add_u32 s101, s101, 22085632
    buffer_store_dwordx4 v[80:83], v84, s[12:15], s101 offen sc1
NORST:
    ds_read_b64_tr_b16 v[36:37], v8 offset:24576
    ds_read_b64_tr_b16 v[38:39], v8 offset:28672
    s_waitcnt lgkmcnt(12)
    v_mfma_f32_16x16x32_bf16 v[48:51], v[16:19], v[96:99], 0
    ds_read_b64_tr_b16 v[40:41], v9 offset:24576
    v_mfma_f32_16x16x32_bf16 v[52:55], v[16:19], v[100:103], 0
    ds_read_b64_tr_b16 v[42:43], v9 offset:28672
    s_waitcnt lgkmcnt(12)
    v_mfma_f32_16x16x32_bf16 v[56:59], v[20:23], v[96:99], 0
    ds_read_b64_tr_b16 v[44:45], v10 offset:24576
    v_mfma_f32_16x16x32_bf16 v[60:63], v[20:23], v[100:103], 0
    ds_read_b64_tr_b16 v[46:47], v10 offset:28672
    s_waitcnt vmcnt(8)
    s_barrier
    s_waitcnt lgkmcnt(12)
    v_mfma_f32_16x16x32_bf16 v[64:67], v[24:27], v[96:99], 0
    ds_read_b128 v[112:115], v5 offset:32768
    ds_read_b128 v[116:119], v5 offset:34816
    s_lshl_b32 s66, s26, 4
    s_add_u32 s66, s66, s27
    s_lshr_b32 s89, s66, 2
    s_lshl_b32 s89, s89, 4
    s_and_b32 s35, s66, 3
    s_lshl_b32 s35, s35, 2
    v_mfma_f32_16x16x32_bf16 v[68:71], v[24:27], v[100:103], 0
    ds_read_b64_tr_b16 v[16:17], v7 offset:49152
    ds_read_b64_tr_b16 v[18:19], v7 offset:53248
    s_add_u32 m0, s60, 131072
    s_nop 0
    buffer_load_dwordx4 v1, s[4:7], s62 offen lds
    s_waitcnt lgkmcnt(14)
    v_mfma_f32_16x16x32_bf16 v[72:75], v[28:31], v[96:99], 0
    ds_read_b64_tr_b16 v[20:21], v8 offset:49152
    s_add_u32 s89, s89, s35
    s_add_u32 s89, s89, 22087680
    s_lshl_b32 s66, s66, 3
    s_add_u32 s66, s66, 22085632
    s_lshl_b32 s84, s26, 1
    s_add_u32 s84, s84, s33
    v_mfma_f32_16x16x32_bf16 v[76:79], v[28:31], v[100:103], 0
    ds_read_b64_tr_b16 v[22:23], v8 offset:53248
    s_add_u32 m0, m0, 1024
    s_nop 0
    buffer_load_dwordx4 v2, s[4:7], s62 offen lds
    s_waitcnt lgkmcnt(12)
    v_mfma_f32_16x16x32_bf16 v[48:51], v[32:35], v[104:107], v[48:51]
    ds_read_b64_tr_b16 v[24:25], v9 offset:49152
    s_lshl_b32 s84, s84, 4
    s_add_u32 s84, s84, s27
    s_lshl_b32 s84, s84, 2
    s_add_u32 s84, s84, s34
    s_lshl_b32 s84, s84, 3
    s_add_u32 s84, s84, 22102016
    v_mfma_f32_16x16x32_bf16 v[52:55], v[32:35], v[108:111], v[52:55]
    ds_read_b64_tr_b16 v[26:27], v9 offset:53248
    s_add_u32 m0, m0, 15360
    s_add_u32 s62, s62, 128
    buffer_load_dwordx4 v3, s[8:11], s63 offen lds
    s_waitcnt lgkmcnt(12)
    v_mfma_f32_16x16x32_bf16 v[56:59], v[36:39], v[104:107], v[56:59]
    ds_read_b64_tr_b16 v[28:29], v10 offset:49152
    s_add_u32 s3, s84, 0x4000
    s_and_b32 s80, s2, 31
    s_lshr_b32 s81, s2, 5
    s_lshl_b32 s85, s81, 2
    s_add_u32 s85, s85, s31
    s_lshl_b32 s85, s85, 5
    v_mfma_f32_16x16x32_bf16 v[60:63], v[36:39], v[108:111], v[60:63]
    ds_read_b64_tr_b16 v[30:31], v10 offset:53248
    s_add_u32 m0, m0, 1024
    s_nop 0
    buffer_load_dwordx4 v4, s[8:11], s63 offen lds
    s_add_u32 s63, s63, s65
    s_cmp_eq_u32 s62, 1280
    s_cselect_b32 s62, 0, s62
    s_cselect_b32 s63, 0, s63
    s_waitcnt lgkmcnt(12)
    v_mfma_f32_16x16x32_bf16 v[64:67], v[40:43], v[104:107], v[64:67]
    ds_read_b128 v[120:123], v6 offset:32768
    ds_read_b128 v[124:127], v6 offset:34816
    s_add_u32 s85, s85, s80
    s_lshl_b32 s85, s85, 1
    s_add_u32 s85, s85, s32
    s_lshl_b32 s85, s85, 3
    s_add_u32 s85, s85, 22134784
    s_lshl_b32 s67, s31, 8
    v_mfma_f32_16x16x32_bf16 v[68:71], v[40:43], v[108:111], v[68:71]
    ds_read_b64_tr_b16 v[32:33], v7 offset:57344
    ds_read_b64_tr_b16 v[34:35], v7 offset:61440
    s_waitcnt lgkmcnt(14)
    v_mfma_f32_16x16x32_bf16 v[72:75], v[44:47], v[104:107], v[72:75]
    ds_read_b64_tr_b16 v[36:37], v8 offset:57344
    s_add_u32 s67, s67, s2
    s_mul_i32 s68, s67, 6554
    s_lshr_b32 s68, s68, 16
    s_mul_i32 s69, s68, 10
    s_sub_u32 s69, s67, s69
    s_lshr_b32 s35, s68, 1
    v_mfma_f32_16x16x32_bf16 v[76:79], v[44:47], v[108:111], v[76:79]
    ds_read_b64_tr_b16 v[38:39], v8 offset:61440
    s_waitcnt lgkmcnt(12)
    v_mfma_f32_16x16x32_bf16 v[48:51], v[16:19], v[112:115], v[48:51]
    ds_read_b64_tr_b16 v[40:41], v9 offset:57344
    s_and_b32 s36, s35, 1
    s_mul_i32 s35, s35, 3
    s_add_u32 s35, s35, s36
    s_and_b32 s36, s68, 1
    s_add_u32 s35, s35, s36
    s_sub_u32 s37, s68, 32
    v_mfma_f32_16x16x32_bf16 v[52:55], v[16:19], v[116:119], v[52:55]
    ds_read_b64_tr_b16 v[42:43], v9 offset:61440
    s_waitcnt lgkmcnt(12)
    v_mfma_f32_16x16x32_bf16 v[56:59], v[20:23], v[112:115], v[56:59]
    ds_read_b64_tr_b16 v[44:45], v10 offset:57344
    s_mul_i32 s37, s37, 3
    s_lshl_b32 s36, s36, 1
    s_sub_u32 s37, s37, s36
    s_add_u32 s37, s37, 2
    s_cmp_lt_u32 s68, 32
    s_cselect_b32 s70, s35, s37
    v_mfma_f32_16x16x32_bf16 v[60:63], v[20:23], v[116:119], v[60:63]
    ds_read_b64_tr_b16 v[46:47], v10 offset:61440
    s_waitcnt vmcnt(8)
    s_barrier
    v_add_u32 v5, 0x10000, v5
    v_add_u32 v6, 0x10000, v6
    v_add_u32 v7, 0x10000, v7
    v_add_u32 v8, 0x10000, v8
    v_add_u32 v9, 0x10000, v9
    v_add_u32 v10, 0x10000, v10
    s_waitcnt lgkmcnt(12)
    v_mfma_f32_16x16x32_bf16 v[64:67], v[24:27], v[112:115], v[64:67]
    ds_read_b128 v[128:131], v5 offset:0
    ds_read_b128 v[132:135], v5 offset:2048
    s_lshl_b32 s70, s70, 5
    s_sub_u32 s71, s68, 48
    s_mul_i32 s71, s71, 40
    s_cmp_lt_u32 s68, 48
    s_cselect_b32 s20, s52, s44
    s_cselect_b32 s21, s53, s45
    s_mov_b32 s22, 819200
    s_cselect_b32 s22, 1966080, s22
    s_mov_b32 s23, 0x20000
    s_cselect_b32 s70, s70, s71
    s_cselect_b32 s76, 16, 20
    s_cselect_b32 s77, 8, 4
    s_cselect_b32 s78, 4, 8
    v_mfma_f32_16x16x32_bf16 v[68:71], v[24:27], v[116:119], v[68:71]
    ds_read_b64_tr_b16 v[16:17], v7 offset:16384
    ds_read_b64_tr_b16 v[18:19], v7 offset:20480
    s_add_u32 m0, s60, 0
    s_nop 0
    buffer_load_dwordx4 v1, s[4:7], s62 offen lds
    s_waitcnt lgkmcnt(14)
    v_mfma_f32_16x16x32_bf16 v[72:75], v[28:31], v[112:115], v[72:75]
    ds_read_b64_tr_b16 v[20:21], v8 offset:16384
    s_sub_u32 s71, s68, 64
    s_mul_i32 s71, s71, 160
    s_add_u32 s71, s71, 16
    s_cmp_lt_u32 s68, 64
    s_cselect_b32 s70, s70, s71
    s_cselect_b32 s76, s76, 0x50
    s_cselect_b32 s77, s77, 40
    s_cselect_b32 s78, s78, 20
    v_mfma_f32_16x16x32_bf16 v[76:79], v[28:31], v[116:119], v[76:79]
    ds_read_b64_tr_b16 v[22:23], v8 offset:20480
    s_add_u32 m0, m0, 1024
    s_nop 0
    buffer_load_dwordx4 v2, s[4:7], s62 offen lds
    s_waitcnt lgkmcnt(12)
    v_mfma_f32_16x16x32_bf16 v[48:51], v[32:35], v[120:123], v[48:51]
    ds_read_b64_tr_b16 v[24:25], v9 offset:16384
    s_mul_i32 s78, s78, s32
    s_add_u32 s70, s70, s78
    s_mul_i32 s70, s70, 1280
    s_mul_i32 s78, s76, 1280
    s_lshl_b32 s71, s69, 7
    s_add_u32 s70, s70, s71
    v_mfma_f32_16x16x32_bf16 v[52:55], v[32:35], v[124:127], v[52:55]
    ds_read_b64_tr_b16 v[26:27], v9 offset:20480
    s_add_u32 m0, m0, 15360
    s_add_u32 s62, s62, 128
    buffer_load_dwordx4 v3, s[8:11], s63 offen lds
    s_waitcnt lgkmcnt(12)
    v_mfma_f32_16x16x32_bf16 v[56:59], v[36:39], v[120:123], v[56:59]
    ds_read_b64_tr_b16 v[28:29], v10 offset:16384
    s_lshl_b32 s79, s26, 2
    s_add_u32 s79, s79, s31
    s_lshl_b32 s79, s79, 7
    s_add_u32 s79, s79, 22020096
    s_mov_b32 s54, s76
    s_mov_b32 s55, s77
    v_mfma_f32_16x16x32_bf16 v[60:63], v[36:39], v[124:127], v[60:63]
    ds_read_b64_tr_b16 v[30:31], v10 offset:20480
    s_add_u32 m0, m0, 1024
    s_nop 0
    buffer_load_dwordx4 v4, s[8:11], s63 offen lds
    s_add_u32 s63, s63, s65
    s_cmp_eq_u32 s62, 1280
    s_cselect_b32 s62, 0, s62
    s_cselect_b32 s63, 0, s63
    s_waitcnt lgkmcnt(12)
    v_mfma_f32_16x16x32_bf16 v[64:67], v[40:43], v[120:123], v[64:67]
    ds_read_b128 v[136:139], v6 offset:0
    ds_read_b128 v[140:143], v6 offset:2048
    s_lshl_b32 s76, s69, 1
    s_add_u32 s76, s76, s32
    s_lshl_b32 s76, s76, 1
    s_add_u32 s77, s76, 1
    s_mul_i32 s35, s76, 13108
    s_lshr_b32 s35, s35, 16
    v_mfma_f32_16x16x32_bf16 v[68:71], v[40:43], v[124:127], v[68:71]
    ds_read_b64_tr_b16 v[32:33], v7 offset:24576
    ds_read_b64_tr_b16 v[34:35], v7 offset:28672
    s_waitcnt lgkmcnt(14)
    v_mfma_f32_16x16x32_bf16 v[72:75], v[44:47], v[120:123], v[72:75]
    ds_read_b64_tr_b16 v[36:37], v8 offset:24576
    s_mul_i32 s36, s35, 5
    s_sub_u32 s36, s76, s36
    s_and_b32 s37, s35, 1
    s_sub_u32 s36, s36, s37
    s_min_u32 s36, s36, 4
    s_mul_i32 s35, s35, 68
    v_mfma_f32_16x16x32_bf16 v[76:79], v[44:47], v[124:127], v[76:79]
    ds_read_b64_tr_b16 v[38:39], v8 offset:28672
    s_waitcnt lgkmcnt(12)
    v_mfma_f32_16x16x32_bf16 v[48:51], v[16:19], v[128:131], v[48:51]
    ds_read_b64_tr_b16 v[40:41], v9 offset:24576
    s_add_u32 s35, s35, s68
    s_mul_i32 s35, s35, 5
    s_add_u32 s35, s35, s36
    s_lshl_b32 s35, s35, 10
    s_add_u32 s35, s35, 18874368
    s_cmp_ge_u32 s67, 680
    s_cselect_b32 s76, 0x7ff00000, s35
    v_mfma_f32_16x16x32_bf16 v[52:55], v[16:19], v[132:135], v[52:55]
    ds_read_b64_tr_b16 v[42:43], v9 offset:28672
    s_waitcnt lgkmcnt(12)
    v_mfma_f32_16x16x32_bf16 v[56:59], v[20:23], v[128:131], v[56:59]
    ds_read_b64_tr_b16 v[44:45], v10 offset:24576
    s_mul_i32 s35, s77, 13108
    s_lshr_b32 s35, s35, 16
    s_mul_i32 s36, s35, 5
    s_sub_u32 s36, s77, s36
    s_and_b32 s37, s35, 1
    s_sub_u32 s36, s36, s37
    v_mfma_f32_16x16x32_bf16 v[60:63], v[20:23], v[132:135], v[60:63]
    ds_read_b64_tr_b16 v[46:47], v10 offset:28672
    s_waitcnt vmcnt(8)
    s_barrier
    s_waitcnt lgkmcnt(12)
    v_mfma_f32_16x16x32_bf16 v[64:67], v[24:27], v[128:131], v[64:67]
    ds_read_b128 v[144:147], v5 offset:32768
    ds_read_b128 v[148:151], v5 offset:34816
    s_min_u32 s36, s36, 4
    s_mul_i32 s35, s35, 68
    s_add_u32 s35, s35, s68
    s_mul_i32 s35, s35, 5
    s_add_u32 s35, s35, s36
    s_lshl_b32 s35, s35, 10
    v_mfma_f32_16x16x32_bf16 v[68:71], v[24:27], v[132:135], v[68:71]
    ds_read_b64_tr_b16 v[16:17], v7 offset:49152
    ds_read_b64_tr_b16 v[18:19], v7 offset:53248
    s_add_u32 m0, s60, 32768
    s_nop 0
    buffer_load_dwordx4 v1, s[4:7], s62 offen lds
    s_waitcnt lgkmcnt(14)
    v_mfma_f32_16x16x32_bf16 v[72:75], v[28:31], v[128:131], v[72:75]
    ds_read_b64_tr_b16 v[20:21], v8 offset:49152
    s_add_u32 s35, s35, 18874368
    s_cmp_ge_u32 s67, 680
    s_cselect_b32 s77, 0x7ff00000, s35
    s_lshr_b32 s35, s26, 1
    s_mul_i32 s35, s35, 480
    s_lshl_b32 s36, s27, 5
    v_mfma_f32_16x16x32_bf16 v[76:79], v[28:31], v[132:135], v[76:79]
    ds_read_b64_tr_b16 v[22:23], v8 offset:53248
    s_add_u32 m0, m0, 1024
    s_nop 0
    buffer_load_dwordx4 v2, s[4:7], s62 offen lds
    s_waitcnt lgkmcnt(12)
    v_mfma_f32_16x16x32_bf16 v[48:51], v[32:35], v[136:139], v[48:51]
    ds_read_b64_tr_b16 v[24:25], v9 offset:49152
    s_branch PN0
.p2align 12
PG0:
    s_branch WARMED
PN0:
    s_add_u32 s35, s35, s36
    s_lshl_b32 s36, s32, 4
    s_add_u32 s35, s35, s36
    s_lshl_b32 s35, s35, 11
    s_and_b32 s36, s26, 1
    s_lshl_b32 s36, s36, 10
    v_mfma_f32_16x16x32_bf16 v[52:55], v[32:35], v[140:143], v[52:55]
    ds_read_b64_tr_b16 v[26:27], v9 offset:53248
    s_add_u32 m0, m0, 15360
    s_add_u32 s62, s62, 128
    buffer_load_dwordx4 v3, s[8:11], s63 offen lds
    s_waitcnt lgkmcnt(12)
    v_mfma_f32_16x16x32_bf16 v[56:59], v[36:39], v[136:139], v[56:59]
    ds_read_b64_tr_b16 v[28:29], v10 offset:49152
    s_add_u32 s35, s35, s36
    s_lshl_b32 s36, s31, 8
    s_add_u32 s35, s35, s36
    s_cmp_eq_u32 s27, 15
    s_cselect_b32 s46, 0x7ff00000, s35
    s_lshl_b32 s35, s26, 1
    v_mfma_f32_16x16x32_bf16 v[60:63], v[36:39], v[140:143], v[60:63]
    ds_read_b64_tr_b16 v[30:31], v10 offset:53248
    s_add_u32 m0, m0, 1024
    s_nop 0
    buffer_load_dwordx4 v4, s[8:11], s63 offen lds
    s_add_u32 s63, s63, s65
    s_cmp_eq_u32 s62, 1280
    s_cselect_b32 s62, 0, s62
    s_cselect_b32 s63, 0, s63
    s_waitcnt lgkmcnt(12)
    v_mfma_f32_16x16x32_bf16 v[64:67], v[40:43], v[136:139], v[64:67]
    ds_read_b128 v[152:155], v6 offset:32768
    ds_read_b128 v[156:159], v6 offset:34816
    s_add_u32 s35, s35, s33
    s_mul_i32 s35, s35, 278528
    s_and_b32 s36, s31, 1
    s_lshl_b32 s36, s36, 9
    s_add_u32 s35, s35, s36
    s_add_u32 s35, s35, 8388608
    v_mfma_f32_16x16x32_bf16 v[68:71], v[40:43], v[140:143], v[68:71]
    ds_read_b64_tr_b16 v[32:33], v7 offset:57344
    ds_read_b64_tr_b16 v[34:35], v7 offset:61440
    s_waitcnt lgkmcnt(14)
    v_mfma_f32_16x16x32_bf16 v[72:75], v[44:47], v[136:139], v[72:75]
    ds_read_b64_tr_b16 v[36:37], v8 offset:57344
    s_lshl_b32 s36, s27, 1
    s_add_u32 s36, s36, s32
    s_lshl_b32 s37, s36, 12
    s_add_u32 s47, s35, s37
    s_lshl_b32 s37, s36, 11
    s_add_u32 s29, s35, s37
    v_mfma_f32_16x16x32_bf16 v[76:79], v[44:47], v[140:143], v[76:79]
    ds_read_b64_tr_b16 v[38:39], v8 offset:61440
    s_waitcnt lgkmcnt(12)
    v_mfma_f32_16x16x32_bf16 v[48:51], v[16:19], v[144:147], v[48:51]
    ds_read_b64_tr_b16 v[40:41], v9 offset:57344
    s_add_u32 s29, s29, 131072
    v_mfma_f32_16x16x32_bf16 v[52:55], v[16:19], v[148:151], v[52:55]
    ds_read_b64_tr_b16 v[42:43], v9 offset:61440
    s_waitcnt lgkmcnt(12)
    v_mfma_f32_16x16x32_bf16 v[56:59], v[20:23], v[144:147], v[56:59]
    ds_read_b64_tr_b16 v[44:45], v10 offset:57344
    v_mfma_f32_16x16x32_bf16 v[60:63], v[20:23], v[148:151], v[60:63]
    ds_read_b64_tr_b16 v[46:47], v10 offset:61440
    s_waitcnt vmcnt(8)
    s_barrier
    v_add_u32 v5, 0x10000, v5
    v_add_u32 v6, 0x10000, v6
    v_add_u32 v7, 0x10000, v7
    v_add_u32 v8, 0x10000, v8
    v_add_u32 v9, 0x10000, v9
    v_add_u32 v10, 0x10000, v10
    s_waitcnt lgkmcnt(12)
    v_mfma_f32_16x16x32_bf16 v[64:67], v[24:27], v[144:147], v[64:67]
    ds_read_b128 v[160:163], v5 offset:0
    ds_read_b128 v[164:167], v5 offset:2048
    v_mfma_f32_16x16x32_bf16 v[68:71], v[24:27], v[148:151], v[68:71]
    ds_read_b64_tr_b16 v[16:17], v7 offset:16384
    ds_read_b64_tr_b16 v[18:19], v7 offset:20480
    s_add_u32 m0, s60, 65536
    s_nop 0
    buffer_load_dwordx4 v1, s[4:7], s62 offen lds
    s_waitcnt lgkmcnt(14)
    v_mfma_f32_16x16x32_bf16 v[72:75], v[28:31], v[144:147], v[72:75]
    ds_read_b64_tr_b16 v[20:21], v8 offset:16384
    v_mfma_f32_16x16x32_bf16 v[76:79], v[28:31], v[148:151], v[76:79]
    ds_read_b64_tr_b16 v[22:23], v8 offset:20480
    s_add_u32 m0, m0, 1024
    s_nop 0
    buffer_load_dwordx4 v2, s[4:7], s62 offen lds
    s_waitcnt lgkmcnt(12)
    v_mfma_f32_16x16x32_bf16 v[48:51], v[32:35], v[152:155], v[48:51]
    ds_read_b64_tr_b16 v[24:25], v9 offset:16384
    v_mfma_f32_16x16x32_bf16 v[52:55], v[32:35], v[156:159], v[52:55]
    ds_read_b64_tr_b16 v[26:27], v9 offset:20480
    s_add_u32 m0, m0, 15360
    s_add_u32 s62, s62, 128
    buffer_load_dwordx4 v3, s[8:11], s63 offen lds
    s_waitcnt lgkmcnt(12)
    v_mfma_f32_16x16x32_bf16 v[56:59], v[36:39], v[152:155], v[56:59]
    ds_read_b64_tr_b16 v[28:29], v10 offset:16384
    v_mfma_f32_16x16x32_bf16 v[60:63], v[36:39], v[156:159], v[60:63]
    ds_read_b64_tr_b16 v[30:31], v10 offset:20480
    s_add_u32 m0, m0, 1024
    s_nop 0
    buffer_load_dwordx4 v4, s[8:11], s63 offen lds
    s_add_u32 s63, s63, s65
    s_cmp_eq_u32 s62, 1280
    s_cselect_b32 s62, 0, s62
    s_cselect_b32 s63, 0, s63
    s_waitcnt lgkmcnt(12)
    v_mfma_f32_16x16x32_bf16 v[64:67], v[40:43], v[152:155], v[64:67]
    ds_read_b128 v[168:171], v6 offset:0
    ds_read_b128 v[172:175], v6 offset:2048
    v_mfma_f32_16x16x32_bf16 v[68:71], v[40:43], v[156:159], v[68:71]
    ds_read_b64_tr_b16 v[32:33], v7 offset:24576
    ds_read_b64_tr_b16 v[34:35], v7 offset:28672
    s_cmp_lg_u32 s100, 0
    s_cbranch_scc1 NOCNT
    v_mov_b32 v11, 1
    s_mov_b64 exec, 1
    buffer_atomic_add v11, off, s[48:51], 0 sc1
    s_mov_b64 exec, -1
NOCNT:
    s_waitcnt lgkmcnt(14)
    v_mfma_f32_16x16x32_bf16 v[72:75], v[44:47], v[152:155], v[72:75]
    ds_read_b64_tr_b16 v[36:37], v8 offset:24576
    v_mfma_f32_16x16x32_bf16 v[76:79], v[44:47], v[156:159], v[76:79]
    ds_read_b64_tr_b16 v[38:39], v8 offset:28672
    s_waitcnt lgkmcnt(12)
    v_mfma_f32_16x16x32_bf16 v[48:51], v[16:19], v[160:163], v[48:51]
    ds_read_b64_tr_b16 v[40:41], v9 offset:24576
    v_mfma_f32_16x16x32_bf16 v[52:55], v[16:19], v[164:167], v[52:55]
    ds_read_b64_tr_b16 v[42:43], v9 offset:28672
    s_waitcnt lgkmcnt(12)
    v_mfma_f32_16x16x32_bf16 v[56:59], v[20:23], v[160:163], v[56:59]
    ds_read_b64_tr_b16 v[44:45], v10 offset:24576
    v_mfma_f32_16x16x32_bf16 v[60:63], v[20:23], v[164:167], v[60:63]
    ds_read_b64_tr_b16 v[46:47], v10 offset:28672
    s_waitcnt vmcnt(8)
    s_barrier
    v_add_u32 v5, 0xfffe0000, v5
    v_add_u32 v6, 0xfffe0000, v6
    v_add_u32 v7, 0xfffe0000, v7
    v_add_u32 v8, 0xfffe0000, v8
    v_add_u32 v9, 0xfffe0000, v9
    v_add_u32 v10, 0xfffe0000, v10
    s_waitcnt lgkmcnt(12)
    v_mfma_f32_16x16x32_bf16 v[64:67], v[24:27], v[160:163], v[64:67]
    ds_read_b128 v[176:179], v5 offset:0
    ds_read_b128 v[180:183], v5 offset:2048
    v_mfma_f32_16x16x32_bf16 v[68:71], v[24:27], v[164:167], v[68:71]
    ds_read_b64_tr_b16 v[16:17], v7 offset:16384
    ds_read_b64_tr_b16 v[18:19], v7 offset:20480
    s_add_u32 m0, s60, 98304
    s_nop 0
    buffer_load_dwordx4 v1, s[4:7], s62 offen lds
    s_waitcnt lgkmcnt(14)
    v_mfma_f32_16x16x32_bf16 v[72:75], v[28:31], v[160:163], v[72:75]
    ds_read_b64_tr_b16 v[20:21], v8 offset:16384
    v_mfma_f32_16x16x32_bf16 v[76:79], v[28:31], v[164:167], v[76:79]
    ds_read_b64_tr_b16 v[22:23], v8 offset:20480
    s_add_u32 m0, m0, 1024
    s_nop 0
    buffer_load_dwordx4 v2, s[4:7], s62 offen lds
    s_waitcnt lgkmcnt(12)
    v_mfma_f32_16x16x32_bf16 v[48:51], v[32:35], v[168:171], v[48:51]
    ds_read_b64_tr_b16 v[24:25], v9 offset:16384
    v_mfma_f32_16x16x32_bf16 v[52:55], v[32:35], v[172:175], v[52:55]
    ds_read_b64_tr_b16 v[26:27], v9 offset:20480
    s_add_u32 m0, m0, 15360
    s_add_u32 s62, s62, 128
    buffer_load_dwordx4 v3, s[8:11], s63 offen lds
    s_waitcnt lgkmcnt(12)
    v_mfma_f32_16x16x32_bf16 v[56:59], v[36:39], v[168:171], v[56:59]
    ds_read_b64_tr_b16 v[28:29], v10 offset:16384
    v_mfma_f32_16x16x32_bf16 v[60:63], v[36:39], v[172:175], v[60:63]
    ds_read_b64_tr_b16 v[30:31], v10 offset:20480
    s_add_u32 m0, m0, 1024
    s_nop 0
    buffer_load_dwordx4 v4, s[8:11], s63 offen lds
    s_add_u32 s63, s63, s65
    s_cmp_eq_u32 s62, 1280
    s_cselect_b32 s62, 0, s62
    s_cselect_b32 s63, 0, s63
    s_waitcnt lgkmcnt(12)
    v_mfma_f32_16x16x32_bf16 v[64:67], v[40:43], v[168:171], v[64:67]
    ds_read_b128 v[184:187], v6 offset:0
    ds_read_b128 v[188:191], v6 offset:2048
    v_mfma_f32_16x16x32_bf16 v[68:71], v[40:43], v[172:175], v[68:71]
    ds_read_b64_tr_b16 v[32:33], v7 offset:24576
    ds_read_b64_tr_b16 v[34:35], v7 offset:28672
    s_waitcnt lgkmcnt(14)
    v_mfma_f32_16x16x32_bf16 v[72:75], v[44:47], v[168:171], v[72:75]
    ds_read_b64_tr_b16 v[36:37], v8 offset:24576
    v_mfma_f32_16x16x32_bf16 v[76:79], v[44:47], v[172:175], v[76:79]
    ds_read_b64_tr_b16 v[38:39], v8 offset:28672
    s_waitcnt lgkmcnt(12)
    v_mfma_f32_16x16x32_bf16 v[48:51], v[16:19], v[176:179], v[48:51]
    ds_read_b64_tr_b16 v[40:41], v9 offset:24576
    v_mfma_f32_16x16x32_bf16 v[52:55], v[16:19], v[180:183], v[52:55]
    ds_read_b64_tr_b16 v[42:43], v9 offset:28672
    s_waitcnt lgkmcnt(12)
    v_mfma_f32_16x16x32_bf16 v[56:59], v[20:23], v[176:179], v[56:59]
    ds_read_b64_tr_b16 v[44:45], v10 offset:24576
    v_mfma_f32_16x16x32_bf16 v[60:63], v[20:23], v[180:183], v[60:63]
    ds_read_b64_tr_b16 v[46:47], v10 offset:28672
    s_waitcnt vmcnt(8)
    s_barrier
    s_waitcnt lgkmcnt(12)
    v_mfma_f32_16x16x32_bf16 v[64:67], v[24:27], v[176:179], v[64:67]
    ds_read_b128 v[192:195], v5 offset:32768
    ds_read_b128 v[196:199], v5 offset:34816
    v_mfma_f32_16x16x32_bf16 v[68:71], v[24:27], v[180:183], v[68:71]
    ds_read_b64_tr_b16 v[16:17], v7 offset:49152
    ds_read_b64_tr_b16 v[18:19], v7 offset:53248
    s_add_u32 m0, s60, 131072
    s_nop 0
    buffer_load_dwordx4 v1, s[4:7], s62 offen lds
    s_waitcnt lgkmcnt(14)
    v_mfma_f32_16x16x32_bf16 v[72:75], v[28:31], v[176:179], v[72:75]
    ds_read_b64_tr_b16 v[20:21], v8 offset:49152
    v_mfma_f32_16x16x32_bf16 v[76:79], v[28:31], v[180:183], v[76:79]
    ds_read_b64_tr_b16 v[22:23], v8 offset:53248
    s_add_u32 m0, m0, 1024
    s_nop 0
    buffer_load_dwordx4 v2, s[4:7], s62 offen lds
    s_waitcnt lgkmcnt(12)
    v_mfma_f32_16x16x32_bf16 v[48:51], v[32:35], v[184:187], v[48:51]
    ds_read_b64_tr_b16 v[24:25], v9 offset:49152
    v_mfma_f32_16x16x32_bf16 v[52:55], v[32:35], v[188:191], v[52:55]
    ds_read_b64_tr_b16 v[26:27], v9 offset:53248
    s_add_u32 m0, m0, 15360
    s_add_u32 s62, s62, 128
    buffer_load_dwordx4 v3, s[8:11], s63 offen lds
    s_waitcnt lgkmcnt(12)
    v_mfma_f32_16x16x32_bf16 v[56:59], v[36:39], v[184:187], v[56:59]
    ds_read_b64_tr_b16 v[28:29], v10 offset:49152
    v_mfma_f32_16x16x32_bf16 v[60:63], v[36:39], v[188:191], v[60:63]
    ds_read_b64_tr_b16 v[30:31], v10 offset:53248
    s_add_u32 m0, m0, 1024
    s_nop 0
    buffer_load_dwordx4 v4, s[8:11], s63 offen lds
    s_add_u32 s63, s63, s65
    s_cmp_eq_u32 s62, 1280
    s_cselect_b32 s62, 0, s62
    s_cselect_b32 s63, 0, s63
    s_waitcnt lgkmcnt(12)
    v_mfma_f32_16x16x32_bf16 v[64:67], v[40:43], v[184:187], v[64:67]
    ds_read_b128 v[200:203], v6 offset:32768
    ds_read_b128 v[204:207], v6 offset:34816
    v_mfma_f32_16x16x32_bf16 v[68:71], v[40:43], v[188:191], v[68:71]
    ds_read_b64_tr_b16 v[32:33], v7 offset:57344
    ds_read_b64_tr_b16 v[34:35], v7 offset:61440
    s_waitcnt lgkmcnt(14)
    v_mfma_f32_16x16x32_bf16 v[72:75], v[44:47], v[184:187], v[72:75]
    ds_read_b64_tr_b16 v[36:37], v8 offset:57344
    v_mfma_f32_16x16x32_bf16 v[76:79], v[44:47], v[188:191], v[76:79]
    ds_read_b64_tr_b16 v[38:39], v8 offset:61440
    s_waitcnt lgkmcnt(12)
    v_mfma_f32_16x16x32_bf16 v[48:51], v[16:19], v[192:195], v[48:51]
    ds_read_b64_tr_b16 v[40:41], v9 offset:57344
    v_mfma_f32_16x16x32_bf16 v[52:55], v[16:19], v[196:199], v[52:55]
    ds_read_b64_tr_b16 v[42:43], v9 offset:61440
    s_waitcnt lgkmcnt(12)
    v_mfma_f32_16x16x32_bf16 v[56:59], v[20:23], v[192:195], v[56:59]
    ds_read_b64_tr_b16 v[44:45], v10 offset:57344
    v_mfma_f32_16x16x32_bf16 v[60:63], v[20:23], v[196:199], v[60:63]
    ds_read_b64_tr_b16 v[46:47], v10 offset:61440
    s_waitcnt vmcnt(8)
    s_barrier
    v_add_u32 v5, 0x10000, v5
    v_add_u32 v6, 0x10000, v6
    v_add_u32 v7, 0x10000, v7
    v_add_u32 v8, 0x10000, v8
    v_add_u32 v9, 0x10000, v9
    v_add_u32 v10, 0x10000, v10
    s_waitcnt lgkmcnt(12)
    v_mfma_f32_16x16x32_bf16 v[64:67], v[24:27], v[192:195], v[64:67]
    ds_read_b128 v[208:211], v5 offset:0
    ds_read_b128 v[212:215], v5 offset:2048
    v_mfma_f32_16x16x32_bf16 v[68:71], v[24:27], v[196:199], v[68:71]
    ds_read_b64_tr_b16 v[16:17], v7 offset:16384
    ds_read_b64_tr_b16 v[18:19], v7 offset:20480
    s_lshr_b32 s35, s34, 1
    s_lshl_b32 s35, s35, 5
    s_lshl_b32 s36, s32, 2
    s_add_u32 s35, s35, s36
    s_mul_i32 s35, s35, 3072
    s_mul_i32 s36, s27, 192
    s_add_u32 s35, s35, s36
    s_and_b32 s36, s27, 1
    s_lshl_b32 s37, s36, 6
    s_add_u32 s37, s37, s35
    s_lshl_b32 s36, s36, 7
    s_sub_u32 s35, s35, s36
    s_add_u32 s35, s35, 128
    v_lshrrev_b32 v11, 3, v0
    v_and_b32 v12, 4, v11
    v_add_u32 v11, v11, v12
    v_mul_u32_u24 v11, 3072, v11
    v_and_b32 v12, 7, v0
    v_lshlrev_b32 v4, 1, v14
    v_xor_b32 v12, v12, v4
    v_lshl_add_u32 v11, v12, 4, v11
    v_add_u32 v1, s37, v11
    v_add_u32 v2, 49152, v1
    s_waitcnt lgkmcnt(14)
    v_mfma_f32_16x16x32_bf16 v[72:75], v[28:31], v[192:195], v[72:75]
    ds_read_b64_tr_b16 v[20:21], v8 offset:16384
    v_mfma_f32_16x16x32_bf16 v[76:79], v[28:31], v[196:199], v[76:79]
    ds_read_b64_tr_b16 v[22:23], v8 offset:20480
    v_lshrrev_b32 v11, 2, v0
    v_and_b32 v12, 12, v11
    v_add_u32 v11, v11, v12
    v_mul_u32_u24 v11, 3072, v11
    v_and_b32 v12, 3, v0
    v_and_b32 v4, 2, v4
    v_xor_b32 v12, v12, v4
    v_lshl_add_u32 v11, v12, 4, v11
    v_add_u32 v3, s35, v11
    s_waitcnt lgkmcnt(12)
    v_mfma_f32_16x16x32_bf16 v[48:51], v[32:35], v[200:203], v[48:51]
    ds_read_b64_tr_b16 v[24:25], v9 offset:16384
    v_mfma_f32_16x16x32_bf16 v[52:55], v[32:35], v[204:207], v[52:55]
    ds_read_b64_tr_b16 v[26:27], v9 offset:20480
    s_add_u32 m0, s60, 0
    s_nop 0
    buffer_load_dwordx4 v1, s[16:19], s64 offen lds
    s_waitcnt lgkmcnt(12)
    v_mfma_f32_16x16x32_bf16 v[56:59], v[36:39], v[200:203], v[56:59]
    ds_read_b64_tr_b16 v[28:29], v10 offset:16384
    v_mfma_f32_16x16x32_bf16 v[60:63], v[36:39], v[204:207], v[60:63]
    ds_read_b64_tr_b16 v[30:31], v10 offset:20480
    s_add_u32 m0, m0, 1024
    s_nop 0
    buffer_load_dwordx4 v2, s[16:19], s64 offen lds
    s_add_u32 s64, s64, 196608
    s_cmp_eq_u32 s64, 1966080
    s_cselect_b32 s64, 0, s64
    s_waitcnt lgkmcnt(12)
    v_mfma_f32_16x16x32_bf16 v[64:67], v[40:43], v[200:203], v[64:67]
    ds_read_b128 v[216:219], v6 offset:0
    ds_read_b128 v[220:223], v6 offset:2048
    v_mfma_f32_16x16x32_bf16 v[68:71], v[40:43], v[204:207], v[68:71]
    ds_read_b64_tr_b16 v[32:33], v7 offset:24576
    ds_read_b64_tr_b16 v[34:35], v7 offset:28672
    s_add_u32 m0, s60, 16384
    s_nop 0
    buffer_load_dwordx4 v1, s[16:19], s64 offen lds
    s_waitcnt lgkmcnt(14)
    v_mfma_f32_16x16x32_bf16 v[72:75], v[44:47], v[200:203], v[72:75]
    ds_read_b64_tr_b16 v[36:37], v8 offset:24576
    v_mfma_f32_16x16x32_bf16 v[76:79], v[44:47], v[204:207], v[76:79]
    ds_read_b64_tr_b16 v[38:39], v8 offset:28672
    s_add_u32 m0, m0, 1024
    s_nop 0
    buffer_load_dwordx4 v2, s[16:19], s64 offen lds
    s_add_u32 s64, s64, 196608
    s_cmp_eq_u32 s64, 1966080
    s_cselect_b32 s64, 0, s64
    s_waitcnt lgkmcnt(12)
    v_mfma_f32_16x16x32_bf16 v[48:51], v[16:19], v[208:211], v[48:51]
    ds_read_b64_tr_b16 v[40:41], v9 offset:24576
    v_mfma_f32_16x16x32_bf16 v[52:55], v[16:19], v[212:215], v[52:55]
    ds_read_b64_tr_b16 v[42:43], v9 offset:28672
    s_waitcnt lgkmcnt(12)
    v_mfma_f32_16x16x32_bf16 v[56:59], v[20:23], v[208:211], v[56:59]
    ds_read_b64_tr_b16 v[44:45], v10 offset:24576
    v_mfma_f32_16x16x32_bf16 v[60:63], v[20:23], v[212:215], v[60:63]
    ds_read_b64_tr_b16 v[46:47], v10 offset:28672
    s_waitcnt vmcnt(8)
    s_barrier
    s_waitcnt lgkmcnt(12)
    v_mfma_f32_16x16x32_bf16 v[64:67], v[24:27], v[208:211], v[64:67]
    ds_read_b128 v[224:227], v5 offset:32768
    ds_read_b128 v[228:231], v5 offset:34816
    v_mfma_f32_16x16x32_bf16 v[68:71], v[24:27], v[212:215], v[68:71]
    ds_read_b64_tr_b16 v[16:17], v7 offset:49152
    ds_read_b64_tr_b16 v[18:19], v7 offset:53248
    s_add_u32 m0, s60, 32768
    s_nop 0
    buffer_load_dwordx4 v1, s[16:19], s64 offen lds
    s_waitcnt lgkmcnt(14)
    v_mfma_f32_16x16x32_bf16 v[72:75], v[28:31], v[208:211], v[72:75]
    ds_read_b64_tr_b16 v[20:21], v8 offset:49152
    v_mfma_f32_16x16x32_bf16 v[76:79], v[28:31], v[212:215], v[76:79]
    ds_read_b64_tr_b16 v[22:23], v8 offset:53248
    s_add_u32 m0, m0, 1024
    s_nop 0
    buffer_load_dwordx4 v2, s[16:19], s64 offen lds
    s_add_u32 s64, s64, 196608
    s_cmp_eq_u32 s64, 1966080
    s_cselect_b32 s64, 0, s64
    s_waitcnt lgkmcnt(12)
    v_mfma_f32_16x16x32_bf16 v[48:51], v[32:35], v[216:219], v[48:51]
    ds_read_b64_tr_b16 v[24:25], v9 offset:49152
    v_mfma_f32_16x16x32_bf16 v[52:55], v[32:35], v[220:223], v[52:55]
    ds_read_b64_tr_b16 v[26:27], v9 offset:53248
    s_add_u32 m0, s60, 49152
    s_nop 0
    buffer_load_dwordx4 v1, s[16:19], s64 offen lds
    s_waitcnt lgkmcnt(12)
    v_mfma_f32_16x16x32_bf16 v[56:59], v[36:39], v[216:219], v[56:59]
    ds_read_b64_tr_b16 v[28:29], v10 offset:49152
    v_mfma_f32_16x16x32_bf16 v[60:63], v[36:39], v[220:223], v[60:63]
    ds_read_b64_tr_b16 v[30:31], v10 offset:53248
    s_add_u32 m0, m0, 1024
    s_nop 0
    buffer_load_dwordx4 v2, s[16:19], s64 offen lds
    s_add_u32 s64, s64, 196608
    s_cmp_eq_u32 s64, 1966080
    s_cselect_b32 s64, 0, s64
    s_waitcnt lgkmcnt(12)
    v_mfma_f32_16x16x32_bf16 v[64:67], v[40:43], v[216:219], v[64:67]
    ds_read_b128 v[232:235], v6 offset:32768
    ds_read_b128 v[236:239], v6 offset:34816
    v_mfma_f32_16x16x32_bf16 v[68:71], v[40:43], v[220:223], v[68:71]
    ds_read_b64_tr_b16 v[32:33], v7 offset:57344
    ds_read_b64_tr_b16 v[34:35], v7 offset:61440
    s_waitcnt lgkmcnt(14)
    v_mfma_f32_16x16x32_bf16 v[72:75], v[44:47], v[216:219], v[72:75]
    ds_read_b64_tr_b16 v[36:37], v8 offset:57344
    v_mfma_f32_16x16x32_bf16 v[76:79], v[44:47], v[220:223], v[76:79]
    ds_read_b64_tr_b16 v[38:39], v8 offset:61440
    s_waitcnt lgkmcnt(12)
    v_mfma_f32_16x16x32_bf16 v[48:51], v[16:19], v[224:227], v[48:51]
    ds_read_b64_tr_b16 v[40:41], v9 offset:57344
    v_mfma_f32_16x16x32_bf16 v[52:55], v[16:19], v[228:231], v[52:55]
    ds_read_b64_tr_b16 v[42:43], v9 offset:61440
    s_waitcnt lgkmcnt(12)
    v_mfma_f32_16x16x32_bf16 v[56:59], v[20:23], v[224:227], v[56:59]
    ds_read_b64_tr_b16 v[44:45], v10 offset:57344
    v_mfma_f32_16x16x32_bf16 v[60:63], v[20:23], v[228:231], v[60:63]
    ds_read_b64_tr_b16 v[46:47], v10 offset:61440
    s_waitcnt vmcnt(8)
    s_barrier
    v_add_u32 v5, 0x10000, v5
    v_add_u32 v6, 0x10000, v6
    v_add_u32 v7, 0x10000, v7
    v_add_u32 v8, 0x10000, v8
    v_add_u32 v9, 0x10000, v9
    v_add_u32 v10, 0x10000, v10
    s_waitcnt lgkmcnt(12)
    v_mfma_f32_16x16x32_bf16 v[64:67], v[24:27], v[224:227], v[64:67]
    ds_read_b128 v[240:243], v5 offset:0
    ds_read_b128 v[244:247], v5 offset:2048
    v_mfma_f32_16x16x32_bf16 v[68:71], v[24:27], v[228:231], v[68:71]
    ds_read_b64_tr_b16 v[16:17], v7 offset:16384
    ds_read_b64_tr_b16 v[18:19], v7 offset:20480
    s_cmp_lg_u32 s30, 0
    s_cbranch_scc1 NOC
    buffer_load_dword v4, off, s[48:51], 0 sc1
NOC:
    s_waitcnt lgkmcnt(14)
    v_mfma_f32_16x16x32_bf16 v[72:75], v[28:31], v[224:227], v[72:75]
    ds_read_b64_tr_b16 v[20:21], v8 offset:16384
    v_mfma_f32_16x16x32_bf16 v[76:79], v[28:31], v[228:231], v[76:79]
    ds_read_b64_tr_b16 v[22:23], v8 offset:20480
    s_add_u32 m0, s60, 65536
    s_nop 0
    buffer_load_dwordx4 v1, s[16:19], s64 offen lds
    s_waitcnt lgkmcnt(12)
    v_mfma_f32_16x16x32_bf16 v[48:51], v[32:35], v[232:235], v[48:51]
    ds_read_b64_tr_b16 v[24:25], v9 offset:16384
    v_mfma_f32_16x16x32_bf16 v[52:55], v[32:35], v[236:239], v[52:55]
    ds_read_b64_tr_b16 v[26:27], v9 offset:20480
    s_add_u32 m0, m0, 1024
    s_nop 0
    buffer_load_dwordx4 v2, s[16:19], s64 offen lds
    s_add_u32 s64, s64, 196608
    s_cmp_eq_u32 s64, 1966080
    s_cselect_b32 s64, 0, s64
    s_waitcnt lgkmcnt(12)
    v_mfma_f32_16x16x32_bf16 v[56:59], v[36:39], v[232:235], v[56:59]
    ds_read_b64_tr_b16 v[28:29], v10 offset:16384
    v_mfma_f32_16x16x32_bf16 v[60:63], v[36:39], v[236:239], v[60:63]
    ds_read_b64_tr_b16 v[30:31], v10 offset:20480
    s_add_u32 m0, s60, 81920
    s_nop 0
    buffer_load_dwordx4 v1, s[16:19], s64 offen lds
    s_waitcnt lgkmcnt(12)
    v_mfma_f32_16x16x32_bf16 v[64:67], v[40:43], v[232:235], v[64:67]
    ds_read_b128 v[248:251], v6 offset:0
    ds_read_b128 v[252:255], v6 offset:2048
    v_mfma_f32_16x16x32_bf16 v[68:71], v[40:43], v[236:239], v[68:71]
    ds_read_b64_tr_b16 v[32:33], v7 offset:24576
    ds_read_b64_tr_b16 v[34:35], v7 offset:28672
    s_add_u32 m0, m0, 1024
    s_nop 0
    buffer_load_dwordx4 v2, s[16:19], s64 offen lds
    s_add_u32 s64, s64, 196608
    s_cmp_eq_u32 s64, 1966080
    s_cselect_b32 s64, 0, s64
    s_waitcnt lgkmcnt(14)
    v_mfma_f32_16x16x32_bf16 v[72:75], v[44:47], v[232:235], v[72:75]
    ds_read_b64_tr_b16 v[36:37], v8 offset:24576
    v_mfma_f32_16x16x32_bf16 v[76:79], v[44:47], v[236:239], v[76:79]
    ds_read_b64_tr_b16 v[38:39], v8 offset:28672
    s_waitcnt lgkmcnt(12)
    v_mfma_f32_16x16x32_bf16 v[48:51], v[16:19], v[240:243], v[48:51]
    ds_read_b64_tr_b16 v[40:41], v9 offset:24576
    v_mfma_f32_16x16x32_bf16 v[52:55], v[16:19], v[244:247], v[52:55]
    ds_read_b64_tr_b16 v[42:43], v9 offset:28672
    s_waitcnt lgkmcnt(12)
    v_mfma_f32_16x16x32_bf16 v[56:59], v[20:23], v[240:243], v[56:59]
    ds_read_b64_tr_b16 v[44:45], v10 offset:24576
    v_mfma_f32_16x16x32_bf16 v[60:63], v[20:23], v[244:247], v[60:63]
    ds_read_b64_tr_b16 v[46:47], v10 offset:28672
    s_waitcnt vmcnt(8)
    s_barrier
    v_lshrrev_b32 v11, 2, v0
    v_and_b32 v12, 3, v0
    v_lshlrev_b32 v12, 3, v12
    v_lshl_add_u32 v9, v11, 6, v12
    v_lshl_add_u32 v12, v11, 7, v12
    v_bfe_u32 v11, v0, 3, 2
    s_lshl_b32 s35, s32, 1
    v_xor_b32 v11, s35, v11
    v_lshl_add_u32 v7, v11, 5, v12
    v_xor_b32 v8, 32, v7
    s_waitcnt lgkmcnt(12)
    v_mfma_f32_16x16x32_bf16 v[64:67], v[24:27], v[240:243], v[64:67]
    ds_read_b64_tr_b16 v[16:17], v7 offset:0
    v_mfma_f32_16x16x32_bf16 v[68:71], v[24:27], v[244:247], v[68:71]
    ds_read_b64_tr_b16 v[18:19], v7 offset:2048
    v_and_b32 v11, 1, v14
    v_xor_b32 v11, s32, v11
    v_lshl_add_u32 v9, v11, 5, v9
    v_add_u32 v9, 49152, v9
    v_lshlrev_b32 v5, 4, v13
    v_lshl_add_u32 v5, v14, 11, v5
    v_lshlrev_b32 v6, 5, v13
    v_and_b32 v12, 1, v14
    v_lshl_add_u32 v6, v12, 4, v6
    v_lshrrev_b32 v12, 1, v14
    v_lshl_add_u32 v6, v12, 10, v6
    s_waitcnt lgkmcnt(12)
    v_mfma_f32_16x16x32_bf16 v[72:75], v[28:31], v[240:243], v[72:75]
    ds_read_b64_tr_b16 v[20:21], v7 offset:8192
    v_mfma_f32_16x16x32_bf16 v[76:79], v[28:31], v[244:247], v[76:79]
    ds_read_b64_tr_b16 v[22:23], v7 offset:10240
    s_add_u32 m0, s60, 98304
    s_nop 0
    buffer_load_dwordx4 v1, s[16:19], s64 offen lds
    s_waitcnt lgkmcnt(10)
    v_mfma_f32_16x16x32_bf16 v[48:51], v[32:35], v[248:251], v[48:51]
    ds_read_b64_tr_b16 v[24:25], v8 offset:0
    v_mfma_f32_16x16x32_bf16 v[52:55], v[32:35], v[252:255], v[52:55]
    ds_read_b64_tr_b16 v[26:27], v8 offset:2048
    s_add_u32 m0, m0, 1024
    s_nop 0
    buffer_load_dwordx4 v2, s[16:19], s64 offen lds
    s_add_u32 s64, s64, 196608
    s_cmp_eq_u32 s64, 1966080
    s_cselect_b32 s64, 0, s64
    s_waitcnt lgkmcnt(10)
    v_mfma_f32_16x16x32_bf16 v[56:59], v[36:39], v[248:251], v[56:59]
    ds_read_b64_tr_b16 v[28:29], v8 offset:8192
    v_mfma_f32_16x16x32_bf16 v[60:63], v[36:39], v[252:255], v[60:63]
    ds_read_b64_tr_b16 v[30:31], v8 offset:10240
    s_add_u32 m0, s60, 114688
    s_nop 0
    buffer_load_dwordx4 v1, s[16:19], s64 offen lds
    s_waitcnt lgkmcnt(10)
    v_mfma_f32_16x16x32_bf16 v[64:67], v[40:43], v[248:251], v[64:67]
    ds_read_b64_tr_b16 v[32:33], v7 offset:4096
    v_mfma_f32_16x16x32_bf16 v[68:71], v[40:43], v[252:255], v[68:71]
    ds_read_b64_tr_b16 v[34:35], v7 offset:6144
    s_add_u32 m0, m0, 1024
    s_nop 0
    buffer_load_dwordx4 v2, s[16:19], s64 offen lds
    s_add_u32 s64, s64, 196608
    s_cmp_eq_u32 s64, 1966080
    s_cselect_b32 s64, 0, s64
    s_waitcnt lgkmcnt(10)
    v_mfma_f32_16x16x32_bf16 v[72:75], v[44:47], v[248:251], v[72:75]
    ds_read_b64_tr_b16 v[36:37], v7 offset:12288
    v_mfma_f32_16x16x32_bf16 v[76:79], v[44:47], v[252:255], v[76:79]
    ds_read_b64_tr_b16 v[38:39], v7 offset:14336
    s_lshl_b32 s35, s27, 1
    s_add_u32 s35, s35, s32
    s_cmp_eq_u32 s35, 30
    s_cbranch_scc1 GATE
GATED:
    v_cvt_pk_bf16_f32 v80, v48, v49
    v_cvt_pk_bf16_f32 v81, v50, v51
    v_cvt_pk_bf16_f32 v82, v52, v53
    v_cvt_pk_bf16_f32 v83, v54, v55
    v_cvt_pk_bf16_f32 v84, v56, v57
    v_cvt_pk_bf16_f32 v85, v58, v59
    v_cvt_pk_bf16_f32 v86, v60, v61
    v_cvt_pk_bf16_f32 v87, v62, v63
    v_cvt_pk_bf16_f32 v88, v64, v65
    v_cvt_pk_bf16_f32 v89, v66, v67
    v_cvt_pk_bf16_f32 v90, v68, v69
    v_cvt_pk_bf16_f32 v91, v70, v71
    v_cvt_pk_bf16_f32 v92, v72, v73
    v_cvt_pk_bf16_f32 v93, v74, v75
    v_cvt_pk_bf16_f32 v94, v76, v77
    v_cvt_pk_bf16_f32 v95, v78, v79
    s_waitcnt lgkmcnt(10)
    v_mfma_f32_16x16x32_bf16 v[48:51], v[16:19], v[96:99], 0
    ds_read_b64_tr_b16 v[40:41], v8 offset:4096
    buffer_store_dwordx4 v[80:83], v5, s[12:15], s46 offen sc1
    s_add_u32 s46, s46, 8192
    v_mfma_f32_16x16x32_bf16 v[52:55], v[16:19], v[100:103], 0
    ds_read_b64_tr_b16 v[42:43], v8 offset:6144
    s_waitcnt lgkmcnt(10)
    s_branch PN1
.p2align 12
PG1:
    s_branch WARMED
PN1:
    v_mfma_f32_16x16x32_bf16 v[56:59], v[20:23], v[96:99], 0
    ds_read_b64_tr_b16 v[44:45], v8 offset:12288
    v_mfma_f32_16x16x32_bf16 v[60:63], v[20:23], v[100:103], 0
    ds_read_b64_tr_b16 v[46:47], v8 offset:14336
    s_waitcnt lgkmcnt(10)
    v_mfma_f32_16x16x32_bf16 v[64:67], v[24:27], v[96:99], 0
    ds_read_b64_tr_b16 v[16:17], v7 offset:16384
    v_mfma_f32_16x16x32_bf16 v[68:71], v[24:27], v[100:103], 0
    ds_read_b64_tr_b16 v[18:19], v7 offset:18432
    s_waitcnt lgkmcnt(10)
    v_mfma_f32_16x16x32_bf16 v[72:75], v[28:31], v[96:99], 0
    ds_read_b64_tr_b16 v[20:21], v7 offset:24576
    v_mfma_f32_16x16x32_bf16 v[76:79], v[28:31], v[100:103], 0
    ds_read_b64_tr_b16 v[22:23], v7 offset:26624
    s_waitcnt lgkmcnt(10)
    v_mfma_f32_16x16x32_bf16 v[48:51], v[32:35], v[104:107], v[48:51]
    ds_read_b64_tr_b16 v[24:25], v8 offset:16384
    v_mfma_f32_16x16x32_bf16 v[52:55], v[32:35], v[108:111], v[52:55]
    ds_read_b64_tr_b16 v[26:27], v8 offset:18432
    s_waitcnt lgkmcnt(10)
    v_mfma_f32_16x16x32_bf16 v[56:59], v[36:39], v[104:107], v[56:59]
    ds_read_b64_tr_b16 v[28:29], v8 offset:24576
    buffer_store_dwordx4 v[84:87], v5, s[12:15], s46 offen sc1
    s_add_u32 s46, s46, 8192
    v_mfma_f32_16x16x32_bf16 v[60:63], v[36:39], v[108:111], v[60:63]
    ds_read_b64_tr_b16 v[30:31], v8 offset:26624
    s_waitcnt lgkmcnt(10)
    v_mfma_f32_16x16x32_bf16 v[64:67], v[40:43], v[104:107], v[64:67]
    ds_read_b64_tr_b16 v[32:33], v7 offset:20480
    v_mfma_f32_16x16x32_bf16 v[68:71], v[40:43], v[108:111], v[68:71]
    ds_read_b64_tr_b16 v[34:35], v7 offset:22528
    s_waitcnt lgkmcnt(10)
    v_mfma_f32_16x16x32_bf16 v[72:75], v[44:47], v[104:107], v[72:75]
    ds_read_b64_tr_b16 v[36:37], v7 offset:28672
    v_mfma_f32_16x16x32_bf16 v[76:79], v[44:47], v[108:111], v[76:79]
    ds_read_b64_tr_b16 v[38:39], v7 offset:30720
    s_waitcnt lgkmcnt(10)
    v_mfma_f32_16x16x32_bf16 v[48:51], v[16:19], v[112:115], v[48:51]
    ds_read_b64_tr_b16 v[40:41], v8 offset:20480
    v_mfma_f32_16x16x32_bf16 v[52:55], v[16:19], v[116:119], v[52:55]
    ds_read_b64_tr_b16 v[42:43], v8 offset:22528
    s_waitcnt lgkmcnt(10)
    v_mfma_f32_16x16x32_bf16 v[56:59], v[20:23], v[112:115], v[56:59]
    ds_read_b64_tr_b16 v[44:45], v8 offset:28672
    v_mfma_f32_16x16x32_bf16 v[60:63], v[20:23], v[116:119], v[60:63]
    ds_read_b64_tr_b16 v[46:47], v8 offset:30720
    s_waitcnt vmcnt(10)
    s_barrier
    s_waitcnt lgkmcnt(10)
    v_mfma_f32_16x16x32_bf16 v[64:67], v[24:27], v[112:115], v[64:67]
    ds_read_b64_tr_b16 v[16:17], v7 offset:32768
    buffer_store_dwordx4 v[88:91], v5, s[12:15], s46 offen sc1
    s_add_u32 s46, s46, 8192
    v_mfma_f32_16x16x32_bf16 v[68:71], v[24:27], v[116:119], v[68:71]
    ds_read_b64_tr_b16 v[18:19], v7 offset:34816
    s_add_u32 m0, s60, 131072
    s_nop 0
    buffer_load_dwordx4 v1, s[16:19], s64 offen lds
    s_waitcnt lgkmcnt(10)
    v_mfma_f32_16x16x32_bf16 v[72:75], v[28:31], v[112:115], v[72:75]
    ds_read_b64_tr_b16 v[20:21], v7 offset:40960
    v_mfma_f32_16x16x32_bf16 v[76:79], v[28:31], v[116:119], v[76:79]
    ds_read_b64_tr_b16 v[22:23], v7 offset:43008
    s_add_u32 m0, m0, 1024
    s_nop 0
    buffer_load_dwordx4 v2, s[16:19], s64 offen lds
    s_add_u32 s64, s64, 196608
    s_cmp_eq_u32 s64, 1966080
    s_cselect_b32 s64, 0, s64
    s_waitcnt lgkmcnt(10)
    v_mfma_f32_16x16x32_bf16 v[48:51], v[32:35], v[120:123], v[48:51]
    ds_read_b64_tr_b16 v[24:25], v8 offset:32768
    v_mfma_f32_16x16x32_bf16 v[52:55], v[32:35], v[124:127], v[52:55]
    ds_read_b64_tr_b16 v[26:27], v8 offset:34816
    s_add_u32 m0, s60, 147456
    s_nop 0
    buffer_load_dwordx4 v1, s[16:19], s64 offen lds
    s_waitcnt lgkmcnt(10)
    v_mfma_f32_16x16x32_bf16 v[56:59], v[36:39], v[120:123], v[56:59]
    ds_read_b64_tr_b16 v[28:29], v8 offset:40960
    v_mfma_f32_16x16x32_bf16 v[60:63], v[36:39], v[124:127], v[60:63]
    ds_read_b64_tr_b16 v[30:31], v8 offset:43008
    s_add_u32 m0, m0, 1024
    s_nop 0
    buffer_load_dwordx4 v2, s[16:19], s64 offen lds
    s_add_u32 s64, s64, 196608
    s_cmp_eq_u32 s64, 1966080
    s_cselect_b32 s64, 0, s64
    s_waitcnt lgkmcnt(10)
    v_mfma_f32_16x16x32_bf16 v[64:67], v[40:43], v[120:123], v[64:67]
    ds_read_b64_tr_b16 v[32:33], v7 offset:36864
    v_mfma_f32_16x16x32_bf16 v[68:71], v[40:43], v[124:127], v[68:71]
    ds_read_b64_tr_b16 v[34:35], v7 offset:38912
    s_waitcnt lgkmcnt(10)
    v_mfma_f32_16x16x32_bf16 v[72:75], v[44:47], v[120:123], v[72:75]
    ds_read_b64_tr_b16 v[36:37], v7 offset:45056
    buffer_store_dwordx4 v[92:95], v5, s[12:15], s46 offen sc1
    s_add_u32 s46, s46, 8192
    v_mfma_f32_16x16x32_bf16 v[76:79], v[44:47], v[124:127], v[76:79]
    ds_read_b64_tr_b16 v[38:39], v7 offset:47104
    s_waitcnt lgkmcnt(10)
    v_mfma_f32_16x16x32_bf16 v[48:51], v[16:19], v[128:131], v[48:51]
    ds_read_b64_tr_b16 v[40:41], v8 offset:36864
    v_mfma_f32_16x16x32_bf16 v[52:55], v[16:19], v[132:135], v[52:55]
    ds_read_b64_tr_b16 v[42:43], v8 offset:38912
    s_waitcnt lgkmcnt(10)
    v_mfma_f32_16x16x32_bf16 v[56:59], v[20:23], v[128:131], v[56:59]
    ds_read_b64_tr_b16 v[44:45], v8 offset:45056
    v_mfma_f32_16x16x32_bf16 v[60:63], v[20:23], v[132:135], v[60:63]
    ds_read_b64_tr_b16 v[46:47], v8 offset:47104
    s_waitcnt lgkmcnt(10)
    v_mfma_f32_16x16x32_bf16 v[64:67], v[24:27], v[128:131], v[64:67]
    ds_read_b64_tr_b16 v[16:17], v7 offset:49152
    v_mfma_f32_16x16x32_bf16 v[68:71], v[24:27], v[132:135], v[68:71]
    ds_read_b64_tr_b16 v[18:19], v7 offset:51200
    s_waitcnt lgkmcnt(10)
    v_mfma_f32_16x16x32_bf16 v[72:75], v[28:31], v[128:131], v[72:75]
    ds_read_b64_tr_b16 v[20:21], v7 offset:57344
    v_mfma_f32_16x16x32_bf16 v[76:79], v[28:31], v[132:135], v[76:79]
    ds_read_b64_tr_b16 v[22:23], v7 offset:59392
    s_waitcnt lgkmcnt(10)
    v_mfma_f32_16x16x32_bf16 v[48:51], v[32:35], v[136:139], v[48:51]
    ds_read_b64_tr_b16 v[24:25], v8 offset:49152
    v_mfma_f32_16x16x32_bf16 v[52:55], v[32:35], v[140:143], v[52:55]
    ds_read_b64_tr_b16 v[26:27], v8 offset:51200
    s_waitcnt lgkmcnt(10)
    v_mfma_f32_16x16x32_bf16 v[56:59], v[36:39], v[136:139], v[56:59]
    ds_read_b64_tr_b16 v[28:29], v8 offset:57344
    v_mfma_f32_16x16x32_bf16 v[60:63], v[36:39], v[140:143], v[60:63]
    ds_read_b64_tr_b16 v[30:31], v8 offset:59392
    s_waitcnt lgkmcnt(10)
    v_mfma_f32_16x16x32_bf16 v[64:67], v[40:43], v[136:139], v[64:67]
    ds_read_b64_tr_b16 v[32:33], v7 offset:53248
    v_mfma_f32_16x16x32_bf16 v[68:71], v[40:43], v[140:143], v[68:71]
    ds_read_b64_tr_b16 v[34:35], v7 offset:55296
    s_waitcnt lgkmcnt(10)
    v_mfma_f32_16x16x32_bf16 v[72:75], v[44:47], v[136:139], v[72:75]
    ds_read_b64_tr_b16 v[36:37], v7 offset:61440
    v_mfma_f32_16x16x32_bf16 v[76:79], v[44:47], v[140:143], v[76:79]
    ds_read_b64_tr_b16 v[38:39], v7 offset:63488
    s_waitcnt lgkmcnt(10)
    v_mfma_f32_16x16x32_bf16 v[48:51], v[16:19], v[144:147], v[48:51]
    ds_read_b64_tr_b16 v[40:41], v8 offset:53248
    v_mfma_f32_16x16x32_bf16 v[52:55], v[16:19], v[148:151], v[52:55]
    ds_read_b64_tr_b16 v[42:43], v8 offset:55296
    s_waitcnt lgkmcnt(10)
    v_mfma_f32_16x16x32_bf16 v[56:59], v[20:23], v[144:147], v[56:59]
    ds_read_b64_tr_b16 v[44:45], v8 offset:61440
    v_mfma_f32_16x16x32_bf16 v[60:63], v[20:23], v[148:151], v[60:63]
    ds_read_b64_tr_b16 v[46:47], v8 offset:63488
    s_waitcnt vmcnt(12)
    s_cmp_lg_u32 s30, 0
    s_cbranch_scc1 NOCHK12
    s_mov_b32 s88, 0
SPIN0:
    v_cmp_gt_u32 vcc, 16, v4
    s_add_u32 s88, s88, 1
    s_nop 0
    s_and_b64 vcc, vcc, 1
    s_cbranch_scc0 GO0
    s_cmp_gt_u32 s88, 0x20000
    s_cbranch_scc1 GO0
    s_sleep 8
    buffer_load_dword v4, off, s[48:51], 0 sc1
    s_waitcnt vmcnt(0)
    s_branch SPIN0
GO0:
NOCHK12:
    s_barrier
    v_add_u32 v7, 0x10000, v7
    v_add_u32 v8, 0x10000, v8
    s_waitcnt lgkmcnt(10)
    v_mfma_f32_16x16x32_bf16 v[64:67], v[24:27], v[144:147], v[64:67]
    ds_read_b64_tr_b16 v[16:17], v7 offset:0
    v_mfma_f32_16x16x32_bf16 v[68:71], v[24:27], v[148:151], v[68:71]
    ds_read_b64_tr_b16 v[18:19], v7 offset:2048
    v_lshrrev_b32 v11, 5, v0
    v_bfe_u32 v12, v0, 3, 2
    v_mad_u32_u24 v11, v11, s55, v12
    v_mul_u32_u24 v11, 1280, v11
    s_waitcnt lgkmcnt(10)
    v_mfma_f32_16x16x32_bf16 v[72:75], v[28:31], v[144:147], v[72:75]
    ds_read_b64_tr_b16 v[20:21], v7 offset:8192
    v_mfma_f32_16x16x32_bf16 v[76:79], v[28:31], v[148:151], v[76:79]
    ds_read_b64_tr_b16 v[22:23], v7 offset:10240
    v_lshlrev_b32 v12, 1, v14
    v_and_b32 v2, 7, v0
    v_xor_b32 v12, v12, v2
    v_lshl_add_u32 v11, v12, 4, v11
    s_waitcnt lgkmcnt(10)
    v_mfma_f32_16x16x32_bf16 v[48:51], v[32:35], v[152:155], v[48:51]
    ds_read_b64_tr_b16 v[24:25], v8 offset:0
    v_mfma_f32_16x16x32_bf16 v[52:55], v[32:35], v[156:159], v[52:55]
    ds_read_b64_tr_b16 v[26:27], v8 offset:2048
    s_add_u32 m0, s60, 0
    s_nop 0
    buffer_load_dwordx4 v11, s[20:23], s70 offen lds
    s_waitcnt lgkmcnt(10)
    v_mfma_f32_16x16x32_bf16 v[56:59], v[36:39], v[152:155], v[56:59]
    ds_read_b64_tr_b16 v[28:29], v8 offset:8192
    v_mfma_f32_16x16x32_bf16 v[60:63], v[36:39], v[156:159], v[60:63]
    ds_read_b64_tr_b16 v[30:31], v8 offset:10240
    s_waitcnt lgkmcnt(10)
    v_mfma_f32_16x16x32_bf16 v[64:67], v[40:43], v[152:155], v[64:67]
    ds_read_b64_tr_b16 v[32:33], v7 offset:4096
    v_mfma_f32_16x16x32_bf16 v[68:71], v[40:43], v[156:159], v[68:71]
    ds_read_b64_tr_b16 v[34:35], v7 offset:6144
    s_waitcnt lgkmcnt(10)
    v_mfma_f32_16x16x32_bf16 v[72:75], v[44:47], v[152:155], v[72:75]
    ds_read_b64_tr_b16 v[36:37], v7 offset:12288
    v_mfma_f32_16x16x32_bf16 v[76:79], v[44:47], v[156:159], v[76:79]
    ds_read_b64_tr_b16 v[38:39], v7 offset:14336
    s_waitcnt lgkmcnt(10)
    v_mfma_f32_16x16x32_bf16 v[48:51], v[16:19], v[160:163], v[48:51]
    ds_read_b64_tr_b16 v[40:41], v8 offset:4096
    v_mfma_f32_16x16x32_bf16 v[52:55], v[16:19], v[164:167], v[52:55]
    ds_read_b64_tr_b16 v[42:43], v8 offset:6144
    s_waitcnt lgkmcnt(10)
    v_mfma_f32_16x16x32_bf16 v[56:59], v[20:23], v[160:163], v[56:59]
    ds_read_b64_tr_b16 v[44:45], v8 offset:12288
    v_mfma_f32_16x16x32_bf16 v[60:63], v[20:23], v[164:167], v[60:63]
    ds_read_b64_tr_b16 v[46:47], v8 offset:14336
    s_add_u32 m0, m0, 1024
    s_add_u32 s70, s70, s78
    buffer_load_dwordx4 v11, s[20:23], s70 offen lds
    s_waitcnt lgkmcnt(10)
    v_mfma_f32_16x16x32_bf16 v[64:67], v[24:27], v[160:163], v[64:67]
    ds_read_b64_tr_b16 v[16:17], v7 offset:16384
    v_mfma_f32_16x16x32_bf16 v[68:71], v[24:27], v[164:167], v[68:71]
    ds_read_b64_tr_b16 v[18:19], v7 offset:18432
    s_waitcnt lgkmcnt(10)
    v_mfma_f32_16x16x32_bf16 v[72:75], v[28:31], v[160:163], v[72:75]
    ds_read_b64_tr_b16 v[20:21], v7 offset:24576
    v_mfma_f32_16x16x32_bf16 v[76:79], v[28:31], v[164:167], v[76:79]
    ds_read_b64_tr_b16 v[22:23], v7 offset:26624
    s_waitcnt lgkmcnt(10)
    v_mfma_f32_16x16x32_bf16 v[48:51], v[32:35], v[168:171], v[48:51]
    ds_read_b64_tr_b16 v[24:25], v8 offset:16384
    v_mfma_f32_16x16x32_bf16 v[52:55], v[32:35], v[172:175], v[52:55]
    ds_read_b64_tr_b16 v[26:27], v8 offset:18432
    s_waitcnt lgkmcnt(10)
    v_mfma_f32_16x16x32_bf16 v[56:59], v[36:39], v[168:171], v[56:59]
    ds_read_b64_tr_b16 v[28:29], v8 offset:24576
    v_mfma_f32_16x16x32_bf16 v[60:63], v[36:39], v[172:175], v[60:63]
    ds_read_b64_tr_b16 v[30:31], v8 offset:26624
    s_waitcnt lgkmcnt(10)
    v_mfma_f32_16x16x32_bf16 v[64:67], v[40:43], v[168:171], v[64:67]
    ds_read_b64_tr_b16 v[32:33], v7 offset:20480
    v_mfma_f32_16x16x32_bf16 v[68:71], v[40:43], v[172:175], v[68:71]
    ds_read_b64_tr_b16 v[34:35], v7 offset:22528
    s_waitcnt lgkmcnt(10)
    v_mfma_f32_16x16x32_bf16 v[72:75], v[44:47], v[168:171], v[72:75]
    ds_read_b64_tr_b16 v[36:37], v7 offset:28672
    v_mfma_f32_16x16x32_bf16 v[76:79], v[44:47], v[172:175], v[76:79]
    ds_read_b64_tr_b16 v[38:39], v7 offset:30720
    s_waitcnt lgkmcnt(10)
    v_mfma_f32_16x16x32_bf16 v[48:51], v[16:19], v[176:179], v[48:51]
    ds_read_b64_tr_b16 v[40:41], v8 offset:20480
    v_mfma_f32_16x16x32_bf16 v[52:55], v[16:19], v[180:183], v[52:55]
    ds_read_b64_tr_b16 v[42:43], v8 offset:22528
    s_waitcnt lgkmcnt(10)
    v_mfma_f32_16x16x32_bf16 v[56:59], v[20:23], v[176:179], v[56:59]
    ds_read_b64_tr_b16 v[44:45], v8 offset:28672
    v_mfma_f32_16x16x32_bf16 v[60:63], v[20:23], v[180:183], v[60:63]
    ds_read_b64_tr_b16 v[46:47], v8 offset:30720
    s_waitcnt vmcnt(2)
    s_barrier
    s_cmp_lg_u32 s30, 0
    s_cbranch_scc1 NOF1
    v_mov_b32 v12, 1
    s_mov_b64 exec, 1
    buffer_store_dword v12, off, s[12:15], s66 sc1
    s_mov_b64 exec, -1
NOF1:
    s_waitcnt lgkmcnt(10)
    v_mfma_f32_16x16x32_bf16 v[64:67], v[24:27], v[176:179], v[64:67]
    ds_read_b64_tr_b16 v[16:17], v7 offset:32768
    v_mfma_f32_16x16x32_bf16 v[68:71], v[24:27], v[180:183], v[68:71]
    ds_read_b64_tr_b16 v[18:19], v7 offset:34816
    s_add_u32 m0, s61, 49152
    s_nop 0
    buffer_load_dwordx4 v3, s[16:19], s64 offen lds
    s_add_u32 s64, s64, 196608
    s_cmp_eq_u32 s64, 1966080
    s_cselect_b32 s64, 0, s64
    s_waitcnt lgkmcnt(10)
    v_mfma_f32_16x16x32_bf16 v[72:75], v[28:31], v[176:179], v[72:75]
    ds_read_b64_tr_b16 v[20:21], v7 offset:40960
    v_mfma_f32_16x16x32_bf16 v[76:79], v[28:31], v[180:183], v[76:79]
    ds_read_b64_tr_b16 v[22:23], v7 offset:43008
    s_add_u32 m0, s61, 57344
    s_nop 0
    buffer_load_dwordx4 v3, s[16:19], s64 offen lds
    s_add_u32 s64, s64, 196608
    s_cmp_eq_u32 s64, 1966080
    s_cselect_b32 s64, 0, s64
    s_waitcnt lgkmcnt(10)
    v_mfma_f32_16x16x32_bf16 v[48:51], v[32:35], v[184:187], v[48:51]
    ds_read_b64_tr_b16 v[24:25], v8 offset:32768
    v_mfma_f32_16x16x32_bf16 v[52:55], v[32:35], v[188:191], v[52:55]
    ds_read_b64_tr_b16 v[26:27], v8 offset:34816
    s_waitcnt lgkmcnt(10)
    v_mfma_f32_16x16x32_bf16 v[56:59], v[36:39], v[184:187], v[56:59]
    ds_read_b64_tr_b16 v[28:29], v8 offset:40960
    v_mfma_f32_16x16x32_bf16 v[60:63], v[36:39], v[188:191], v[60:63]
    ds_read_b64_tr_b16 v[30:31], v8 offset:43008
    s_waitcnt lgkmcnt(10)
    v_mfma_f32_16x16x32_bf16 v[64:67], v[40:43], v[184:187], v[64:67]
    ds_read_b64_tr_b16 v[32:33], v7 offset:36864
    v_mfma_f32_16x16x32_bf16 v[68:71], v[40:43], v[188:191], v[68:71]
    ds_read_b64_tr_b16 v[34:35], v7 offset:38912
    s_waitcnt lgkmcnt(10)
    v_mfma_f32_16x16x32_bf16 v[72:75], v[44:47], v[184:187], v[72:75]
    ds_read_b64_tr_b16 v[36:37], v7 offset:45056
    v_mfma_f32_16x16x32_bf16 v[76:79], v[44:47], v[188:191], v[76:79]
    ds_read_b64_tr_b16 v[38:39], v7 offset:47104
    s_waitcnt lgkmcnt(10)
    v_mfma_f32_16x16x32_bf16 v[48:51], v[16:19], v[192:195], v[48:51]
    ds_read_b64_tr_b16 v[40:41], v8 offset:36864
    v_mfma_f32_16x16x32_bf16 v[52:55], v[16:19], v[196:199], v[52:55]
    ds_read_b64_tr_b16 v[42:43], v8 offset:38912
    s_waitcnt lgkmcnt(10)
    v_mfma_f32_16x16x32_bf16 v[56:59], v[20:23], v[192:195], v[56:59]
    ds_read_b64_tr_b16 v[44:45], v8 offset:45056
    v_mfma_f32_16x16x32_bf16 v[60:63], v[20:23], v[196:199], v[60:63]
    ds_read_b64_tr_b16 v[46:47], v8 offset:47104
    s_waitcnt lgkmcnt(10)
    v_mfma_f32_16x16x32_bf16 v[64:67], v[24:27], v[192:195], v[64:67]
    ds_read_b64_tr_b16 v[16:17], v7 offset:49152
    v_mfma_f32_16x16x32_bf16 v[68:71], v[24:27], v[196:199], v[68:71]
    ds_read_b64_tr_b16 v[18:19], v7 offset:51200
    s_waitcnt lgkmcnt(10)
    v_mfma_f32_16x16x32_bf16 v[72:75], v[28:31], v[192:195], v[72:75]
    ds_read_b64_tr_b16 v[20:21], v7 offset:57344
    v_mfma_f32_16x16x32_bf16 v[76:79], v[28:31], v[196:199], v[76:79]
    ds_read_b64_tr_b16 v[22:23], v7 offset:59392
    s_waitcnt lgkmcnt(10)
    v_mfma_f32_16x16x32_bf16 v[48:51], v[32:35], v[200:203], v[48:51]
    ds_read_b64_tr_b16 v[24:25], v8 offset:49152
    v_mfma_f32_16x16x32_bf16 v[52:55], v[32:35], v[204:207], v[52:55]
    ds_read_b64_tr_b16 v[26:27], v8 offset:51200
    s_waitcnt lgkmcnt(10)
    v_mfma_f32_16x16x32_bf16 v[56:59], v[36:39], v[200:203], v[56:59]
    ds_read_b64_tr_b16 v[28:29], v8 offset:57344
    v_mfma_f32_16x16x32_bf16 v[60:63], v[36:39], v[204:207], v[60:63]
    ds_read_b64_tr_b16 v[30:31], v8 offset:59392
    s_waitcnt lgkmcnt(10)
    v_mfma_f32_16x16x32_bf16 v[64:67], v[40:43], v[200:203], v[64:67]
    ds_read_b64_tr_b16 v[32:33], v7 offset:53248
    v_mfma_f32_16x16x32_bf16 v[68:71], v[40:43], v[204:207], v[68:71]
    ds_read_b64_tr_b16 v[34:35], v7 offset:55296
    s_waitcnt lgkmcnt(10)
    v_mfma_f32_16x16x32_bf16 v[72:75], v[44:47], v[200:203], v[72:75]
    ds_read_b64_tr_b16 v[36:37], v7 offset:61440
    v_mfma_f32_16x16x32_bf16 v[76:79], v[44:47], v[204:207], v[76:79]
    ds_read_b64_tr_b16 v[38:39], v7 offset:63488
    s_waitcnt lgkmcnt(10)
    v_mfma_f32_16x16x32_bf16 v[48:51], v[16:19], v[208:211], v[48:51]
    ds_read_b64_tr_b16 v[40:41], v8 offset:53248
    v_mfma_f32_16x16x32_bf16 v[52:55], v[16:19], v[212:215], v[52:55]
    ds_read_b64_tr_b16 v[42:43], v8 offset:55296
    s_waitcnt lgkmcnt(10)
    v_mfma_f32_16x16x32_bf16 v[56:59], v[20:23], v[208:211], v[56:59]
    ds_read_b64_tr_b16 v[44:45], v8 offset:61440
    v_mfma_f32_16x16x32_bf16 v[60:63], v[20:23], v[212:215], v[60:63]
    ds_read_b64_tr_b16 v[46:47], v8 offset:63488
    s_waitcnt vmcnt(2)
    s_barrier
    v_add_u32 v7, 0x10000, v7
    v_add_u32 v8, 0x10000, v8
    s_waitcnt lgkmcnt(10)
    v_mfma_f32_16x16x32_bf16 v[64:67], v[24:27], v[208:211], v[64:67]
    ds_read_b64_tr_b16 v[16:17], v7 offset:0
    s_lshl_b32 s35, s31, 12
    s_add_u32 s35, s35, 0
    v_and_b32 v11, 0xfff, v7
    v_add_u32 v11, s35, v11
    v_xor_b32 v12, 32, v11
    v_lshlrev_b32 v5, 4, v0
    v_mfma_f32_16x16x32_bf16 v[68:71], v[24:27], v[212:215], v[68:71]
    ds_read_b64_tr_b16 v[18:19], v7 offset:2048
    s_add_u32 m0, s61, 65536
    s_nop 0
    buffer_load_dwordx4 v3, s[16:19], s64 offen lds
    s_add_u32 s64, s64, 196608
    s_cmp_eq_u32 s64, 1966080
    s_cselect_b32 s64, 0, s64
    s_waitcnt lgkmcnt(10)
    v_mfma_f32_16x16x32_bf16 v[72:75], v[28:31], v[208:211], v[72:75]
    ds_read_b64_tr_b16 v[20:21], v7 offset:8192
    ds_read_b64_tr_b16 v[80:81], v11 offset:0
    ds_read_b64_tr_b16 v[82:83], v11 offset:2048
    v_mfma_f32_16x16x32_bf16 v[76:79], v[28:31], v[212:215], v[76:79]
    ds_read_b64_tr_b16 v[22:23], v7 offset:10240
    s_add_u32 m0, s61, 73728
    s_nop 0
    buffer_load_dwordx4 v3, s[16:19], s64 offen lds
    s_add_u32 s64, s64, 196608
    s_cmp_eq_u32 s64, 1966080
    s_cselect_b32 s64, 0, s64
    s_waitcnt lgkmcnt(12)
    v_mfma_f32_16x16x32_bf16 v[48:51], v[32:35], v[216:219], v[48:51]
    ds_read_b64_tr_b16 v[24:25], v8 offset:0
    ds_read_b64_tr_b16 v[84:85], v12 offset:0
    ds_read_b64_tr_b16 v[86:87], v12 offset:2048
    v_mfma_f32_16x16x32_bf16 v[52:55], v[32:35], v[220:223], v[52:55]
    ds_read_b64_tr_b16 v[26:27], v8 offset:2048
    s_waitcnt lgkmcnt(14)
    v_mfma_f32_16x16x32_bf16 v[56:59], v[36:39], v[216:219], v[56:59]
    ds_read_b64_tr_b16 v[28:29], v8 offset:8192
    v_mfma_f32_16x16x32_bf16 v[60:63], v[36:39], v[220:223], v[60:63]
    ds_read_b64_tr_b16 v[30:31], v8 offset:10240
    s_waitcnt lgkmcnt(14)
    v_mfma_f32_16x16x32_bf16 v[64:67], v[40:43], v[216:219], v[64:67]
    ds_read_b64_tr_b16 v[32:33], v7 offset:4096
    v_mfma_f32_16x16x32_bf16 v[68:71], v[40:43], v[220:223], v[68:71]
    ds_read_b64_tr_b16 v[34:35], v7 offset:6144
    s_waitcnt lgkmcnt(14)
    v_mfma_f32_16x16x32_bf16 v[72:75], v[44:47], v[216:219], v[72:75]
    ds_read_b64_tr_b16 v[36:37], v7 offset:12288
    v_mfma_f32_16x16x32_bf16 v[76:79], v[44:47], v[220:223], v[76:79]
    ds_read_b64_tr_b16 v[38:39], v7 offset:14336
    s_waitcnt lgkmcnt(14)
    v_mfma_f32_16x16x32_bf16 v[48:51], v[16:19], v[224:227], v[48:51]
    ds_read_b64_tr_b16 v[40:41], v8 offset:4096
    v_mfma_f32_16x16x32_bf16 v[52:55], v[16:19], v[228:231], v[52:55]
    ds_read_b64_tr_b16 v[42:43], v8 offset:6144
    s_waitcnt lgkmcnt(12)
    v_mfma_f32_16x16x32_bf16 v[56:59], v[20:23], v[224:227], v[56:59]
    ds_read_b64_tr_b16 v[44:45], v8 offset:12288
    v_mfma_f32_16x16x32_bf16 v[60:63], v[20:23], v[228:231], v[60:63]
    ds_read_b64_tr_b16 v[46:47], v8 offset:14336
    s_waitcnt lgkmcnt(10)
    v_mfma_f32_16x16x32_bf16 v[64:67], v[24:27], v[224:227], v[64:67]
    ds_read_b64_tr_b16 v[16:17], v7 offset:16384
    buffer_store_dwordx4 v[80:83], v5, s[12:15], s76 offen sc1
    v_mfma_f32_16x16x32_bf16 v[68:71], v[24:27], v[228:231], v[68:71]
    ds_read_b64_tr_b16 v[18:19], v7 offset:18432
    s_waitcnt lgkmcnt(10)
    v_mfma_f32_16x16x32_bf16 v[72:75], v[28:31], v[224:227], v[72:75]
    ds_read_b64_tr_b16 v[20:21], v7 offset:24576
    v_mfma_f32_16x16x32_bf16 v[76:79], v[28:31], v[228:231], v[76:79]
    ds_read_b64_tr_b16 v[22:23], v7 offset:26624
    s_waitcnt lgkmcnt(10)
    v_mfma_f32_16x16x32_bf16 v[48:51], v[32:35], v[232:235], v[48:51]
    ds_read_b64_tr_b16 v[24:25], v8 offset:16384
    v_mfma_f32_16x16x32_bf16 v[52:55], v[32:35], v[236:239], v[52:55]
    ds_read_b64_tr_b16 v[26:27], v8 offset:18432
    s_lshl_b32 s35, s81, 5
    s_sub_u32 s35, s35, 32
    v_add_u32 v10, s35, v0
    v_and_b32 v10, 0xff, v10
    v_lshlrev_b32 v10, 3, v10
    s_mov_b32 s83, 22085632
    s_cmp_lg_u32 s30, 0
    s_cbranch_scc1 NOP1
    buffer_load_dword v4, v10, s[12:15], s83 offen sc1
NOP1:
    s_waitcnt lgkmcnt(10)
    v_mfma_f32_16x16x32_bf16 v[56:59], v[36:39], v[232:235], v[56:59]
    ds_read_b64_tr_b16 v[28:29], v8 offset:24576
    v_mfma_f32_16x16x32_bf16 v[60:63], v[36:39], v[236:239], v[60:63]
    ds_read_b64_tr_b16 v[30:31], v8 offset:26624
    s_add_u32 m0, s61, 81920
    s_nop 0
    buffer_load_dwordx4 v3, s[16:19], s64 offen lds
    s_add_u32 s64, s64, 196608
    s_cmp_eq_u32 s64, 1966080
    s_cselect_b32 s64, 0, s64
    s_waitcnt lgkmcnt(10)
    v_mfma_f32_16x16x32_bf16 v[64:67], v[40:43], v[232:235], v[64:67]
    ds_read_b64_tr_b16 v[32:33], v7 offset:20480
    v_mfma_f32_16x16x32_bf16 v[68:71], v[40:43], v[236:239], v[68:71]
    ds_read_b64_tr_b16 v[34:35], v7 offset:22528
    s_add_u32 m0, s61, 90112
    s_nop 0
    buffer_load_dwordx4 v3, s[16:19], s64 offen lds
    s_add_u32 s64, s64, 196608
    s_cmp_eq_u32 s64, 1966080
    s_cselect_b32 s64, 0, s64
    s_waitcnt lgkmcnt(10)
    v_mfma_f32_16x16x32_bf16 v[72:75], v[44:47], v[232:235], v[72:75]
    ds_read_b64_tr_b16 v[36:37], v7 offset:28672
    v_mfma_f32_16x16x32_bf16 v[76:79], v[44:47], v[236:239], v[76:79]
    ds_read_b64_tr_b16 v[38:39], v7 offset:30720
    s_waitcnt lgkmcnt(10)
    v_mfma_f32_16x16x32_bf16 v[48:51], v[16:19], v[240:243], v[48:51]
    ds_read_b64_tr_b16 v[40:41], v8 offset:20480
    buffer_store_dwordx4 v[84:87], v5, s[12:15], s77 offen sc1
    v_mfma_f32_16x16x32_bf16 v[52:55], v[16:19], v[244:247], v[52:55]
    ds_read_b64_tr_b16 v[42:43], v8 offset:22528
    s_waitcnt lgkmcnt(10)
    v_mfma_f32_16x16x32_bf16 v[56:59], v[20:23], v[240:243], v[56:59]
    ds_read_b64_tr_b16 v[44:45], v8 offset:28672
    v_mfma_f32_16x16x32_bf16 v[60:63], v[20:23], v[244:247], v[60:63]
    ds_read_b64_tr_b16 v[46:47], v8 offset:30720
    s_waitcnt vmcnt(6)
    s_cmp_lg_u32 s30, 0
    s_cbranch_scc1 NOCHK15
    s_waitcnt vmcnt(3)
    s_mov_b32 s88, 0
SPIN1:
    v_cmp_gt_u32 vcc, 1, v4
    s_add_u32 s88, s88, 1
    s_nop 0
    s_and_b64 vcc, vcc, -1
    s_cbranch_scc0 GO1
    s_cmp_gt_u32 s88, 0x20000
    s_cbranch_scc1 GO1
    s_sleep 8
    buffer_load_dword v4, v10, s[12:15], s83 offen sc1
    s_waitcnt vmcnt(0)
    s_branch SPIN1
GO1:
NOCHK15:
    s_barrier
    s_waitcnt lgkmcnt(10)
    v_mfma_f32_16x16x32_bf16 v[64:67], v[24:27], v[240:243], v[64:67]
    ds_read_b64_tr_b16 v[16:17], v9 offset:0
    v_mfma_f32_16x16x32_bf16 v[68:71], v[24:27], v[244:247], v[68:71]
    ds_read_b64_tr_b16 v[18:19], v9 offset:1024
    s_add_u32 m0, s61, 98304
    s_nop 0
    buffer_load_dwordx4 v3, s[16:19], s64 offen lds
    s_add_u32 s64, s64, 196608
    s_cmp_eq_u32 s64, 1966080
    s_cselect_b32 s64, 0, s64
    s_waitcnt lgkmcnt(10)
    v_mfma_f32_16x16x32_bf16 v[72:75], v[28:31], v[240:243], v[72:75]
    ds_read_b64_tr_b16 v[20:21], v9 offset:4096
    v_mfma_f32_16x16x32_bf16 v[76:79], v[28:31], v[244:247], v[76:79]
    ds_read_b64_tr_b16 v[22:23], v9 offset:5120
    s_add_u32 m0, s61, 106496
    s_nop 0
    buffer_load_dwordx4 v3, s[16:19], s64 offen lds
    s_add_u32 s64, s64, 196608
    s_cmp_eq_u32 s64, 1966080
    s_cselect_b32 s64, 0, s64
    s_waitcnt lgkmcnt(10)
    v_mfma_f32_16x16x32_bf16 v[48:51], v[32:35], v[248:251], v[48:51]
    ds_read_b64_tr_b16 v[24:25], v9 offset:2048
    v_mfma_f32_16x16x32_bf16 v[52:55], v[32:35], v[252:255], v[52:55]
    ds_read_b64_tr_b16 v[26:27], v9 offset:3072
    s_add_u32 m0, s61, 114688
    s_nop 0
    buffer_load_dwordx4 v3, s[16:19], s64 offen lds
    s_add_u32 s64, s64, 196608
    s_cmp_eq_u32 s64, 1966080
    s_cselect_b32 s64, 0, s64
    s_waitcnt lgkmcnt(10)
    v_mfma_f32_16x16x32_bf16 v[56:59], v[36:39], v[248:251], v[56:59]
    ds_read_b64_tr_b16 v[28:29], v9 offset:6144
    v_mfma_f32_16x16x32_bf16 v[60:63], v[36:39], v[252:255], v[60:63]
    ds_read_b64_tr_b16 v[30:31], v9 offset:7168
    s_add_u32 m0, s61, 122880
    s_nop 0
    buffer_load_dwordx4 v3, s[16:19], s64 offen lds
    s_add_u32 s64, s64, 196608
    s_cmp_eq_u32 s64, 1966080
    s_cselect_b32 s64, 0, s64
    s_waitcnt lgkmcnt(10)
    v_mfma_f32_16x16x32_bf16 v[64:67], v[40:43], v[248:251], v[64:67]
    ds_read_b64_tr_b16 v[32:33], v9 offset:8192
    v_mfma_f32_16x16x32_bf16 v[68:71], v[40:43], v[252:255], v[68:71]
    ds_read_b64_tr_b16 v[34:35], v9 offset:9216
    s_lshr_b32 s35, s34, 1
    s_add_u32 s35, s35, s81
    s_add_u32 s35, s35, 7
    s_and_b32 s35, s35, 7
    s_mul_i32 s35, s35, 480
    s_mul_i32 s82, s80, 5
    s_add_u32 s37, s33, 1
    s_mul_i32 s37, s37, 160
    s_add_u32 s35, s35, s82
    s_add_u32 s35, s35, s37
    s_lshl_b32 s35, s35, 11
    s_lshl_b32 s37, s32, 10
    s_add_u32 s35, s35, s37
    s_mul_i32 s37, s33, 20640
    s_lshl_b32 s38, s34, 10
    s_add_u32 s52, s37, s38
    s_mov_b32 s53, s35
    v_lshlrev_b32 v1, 4, v0
    s_waitcnt lgkmcnt(10)
    v_mfma_f32_16x16x32_bf16 v[72:75], v[44:47], v[248:251], v[72:75]
    ds_read_b64_tr_b16 v[36:37], v9 offset:12288
    v_mfma_f32_16x16x32_bf16 v[76:79], v[44:47], v[252:255], v[76:79]
    ds_read_b64_tr_b16 v[38:39], v9 offset:13312
    s_add_u32 m0, s52, 0
    s_nop 0
    buffer_load_dwordx4 v1, s[12:15], s53 offen sc1 lds
    s_add_u32 s53, s53, 2048
    s_waitcnt lgkmcnt(10)
    v_mfma_f32_16x16x32_bf16 v[80:83], v[16:19], v[96:99], 0
    ds_read_b64_tr_b16 v[40:41], v9 offset:10240
    v_mfma_f32_16x16x32_bf16 v[84:87], v[16:19], v[100:103], 0
    ds_read_b64_tr_b16 v[42:43], v9 offset:11264
    s_add_u32 m0, s52, 4128
    s_nop 0
    buffer_load_dwordx4 v1, s[12:15], s53 offen sc1 lds
    s_add_u32 s53, s53, 2048
    s_waitcnt lgkmcnt(10)
    v_mfma_f32_16x16x32_bf16 v[88:91], v[20:23], v[96:99], 0
    ds_read_b64_tr_b16 v[44:45], v9 offset:14336
    v_mul_f32 v56, v48, v56
    v_mul_f32 v48, 0xbfb8aa3b, v48
    v_mul_f32 v57, v49, v57
    v_mul_f32 v49, 0xbfb8aa3b, v49
    v_mul_f32 v58, v50, v58
    v_mul_f32 v50, 0xbfb8aa3b, v50
    v_mul_f32 v59, v51, v59
    v_mul_f32 v51, 0xbfb8aa3b, v51
    s_branch PN2
.p2align 12
PG2:
    s_branch WARMED
PN2:
    v_mfma_f32_16x16x32_bf16 v[92:95], v[20:23], v[100:103], 0
    ds_read_b64_tr_b16 v[46:47], v9 offset:15360
    s_waitcnt vmcnt(10)
    s_barrier
    s_waitcnt lgkmcnt(10)
    v_mfma_f32_16x16x32_bf16 v[80:83], v[24:27], v[104:107], v[80:83]
    ds_read_b64_tr_b16 v[16:17], v9 offset:16384
    v_mul_f32 v60, v52, v60
    v_mul_f32 v52, 0xbfb8aa3b, v52
    v_mul_f32 v61, v53, v61
    v_mul_f32 v53, 0xbfb8aa3b, v53
    v_mul_f32 v62, v54, v62
    v_mul_f32 v54, 0xbfb8aa3b, v54
    v_mul_f32 v63, v55, v63
    v_mul_f32 v55, 0xbfb8aa3b, v55
    v_mfma_f32_16x16x32_bf16 v[84:87], v[24:27], v[108:111], v[84:87]
    ds_read_b64_tr_b16 v[18:19], v9 offset:17408
    s_add_u32 m0, s52, 8256
    s_nop 0
    buffer_load_dwordx4 v1, s[12:15], s53 offen sc1 lds
    s_add_u32 s53, s53, 2048
    s_waitcnt lgkmcnt(10)
    v_mfma_f32_16x16x32_bf16 v[88:91], v[28:31], v[104:107], v[88:91]
    ds_read_b64_tr_b16 v[20:21], v9 offset:20480
    v_exp_f32 v48, v48
    v_exp_f32 v49, v49
    v_exp_f32 v50, v50
    v_exp_f32 v51, v51
    v_mfma_f32_16x16x32_bf16 v[92:95], v[28:31], v[108:111], v[92:95]
    ds_read_b64_tr_b16 v[22:23], v9 offset:21504
    s_waitcnt lgkmcnt(10)
    v_mfma_f32_16x16x32_bf16 v[80:83], v[32:35], v[112:115], v[80:83]
    ds_read_b64_tr_b16 v[24:25], v9 offset:18432
    v_exp_f32 v52, v52
    v_exp_f32 v53, v53
    v_exp_f32 v54, v54
    v_exp_f32 v55, v55
    v_mfma_f32_16x16x32_bf16 v[84:87], v[32:35], v[116:119], v[84:87]
    ds_read_b64_tr_b16 v[26:27], v9 offset:19456
    s_waitcnt lgkmcnt(10)
    v_mfma_f32_16x16x32_bf16 v[88:91], v[36:39], v[112:115], v[88:91]
    ds_read_b64_tr_b16 v[28:29], v9 offset:22528
    v_add_f32 v48, 1.0, v48
    v_add_f32 v49, 1.0, v49
    v_add_f32 v50, 1.0, v50
    v_add_f32 v51, 1.0, v51
    v_mfma_f32_16x16x32_bf16 v[92:95], v[36:39], v[116:119], v[92:95]
    ds_read_b64_tr_b16 v[30:31], v9 offset:23552
    s_add_u32 m0, s52, 12384
    s_nop 0
    buffer_load_dwordx4 v1, s[12:15], s53 offen sc1 lds
    s_add_u32 s53, s53, 2048
    s_waitcnt lgkmcnt(10)
    v_mfma_f32_16x16x32_bf16 v[80:83], v[40:43], v[120:123], v[80:83]
    ds_read_b64_tr_b16 v[32:33], v9 offset:24576
    v_add_f32 v52, 1.0, v52
    v_add_f32 v53, 1.0, v53
    v_add_f32 v54, 1.0, v54
    v_add_f32 v55, 1.0, v55
    v_mfma_f32_16x16x32_bf16 v[84:87], v[40:43], v[124:127], v[84:87]
    ds_read_b64_tr_b16 v[34:35], v9 offset:25600
    s_waitcnt lgkmcnt(10)
    v_mfma_f32_16x16x32_bf16 v[88:91], v[44:47], v[120:123], v[88:91]
    ds_read_b64_tr_b16 v[36:37], v9 offset:28672
    v_rcp_f32 v48, v48
    v_rcp_f32 v49, v49
    v_rcp_f32 v50, v50
    v_rcp_f32 v51, v51
    v_mfma_f32_16x16x32_bf16 v[92:95], v[44:47], v[124:127], v[92:95]
    ds_read_b64_tr_b16 v[38:39], v9 offset:29696
    s_waitcnt lgkmcnt(10)
    v_mfma_f32_16x16x32_bf16 v[80:83], v[16:19], v[128:131], v[80:83]
    ds_read_b64_tr_b16 v[40:41], v9 offset:26624
    v_rcp_f32 v52, v52
    v_rcp_f32 v53, v53
    v_rcp_f32 v54, v54
    v_rcp_f32 v55, v55
    v_mfma_f32_16x16x32_bf16 v[84:87], v[16:19], v[132:135], v[84:87]
    ds_read_b64_tr_b16 v[42:43], v9 offset:27648
    s_add_u32 m0, s52, 16512
    s_nop 0
    buffer_load_dwordx4 v1, s[12:15], s53 offen sc1 lds
    s_add_u32 s53, s53, 2048
    s_waitcnt lgkmcnt(10)
    v_mfma_f32_16x16x32_bf16 v[88:91], v[20:23], v[128:131], v[88:91]
    ds_read_b64_tr_b16 v[44:45], v9 offset:30720
    v_mul_f32 v48, v48, v56
    v_mul_f32 v49, v49, v57
    v_mul_f32 v50, v50, v58
    v_mul_f32 v51, v51, v59
    v_mfma_f32_16x16x32_bf16 v[92:95], v[20:23], v[132:135], v[92:95]
    ds_read_b64_tr_b16 v[46:47], v9 offset:31744
    s_waitcnt vmcnt(9)
    s_barrier
    s_cmp_lg_u32 s30, 0
    s_cbranch_scc1 NOF1B
    v_mov_b32 v4, 1
    s_mov_b64 exec, 1
    buffer_store_dword v4, off, s[12:15], s89 sc1
    s_mov_b64 exec, -1
NOF1B:
    s_waitcnt lgkmcnt(10)
    v_mfma_f32_16x16x32_bf16 v[80:83], v[24:27], v[136:139], v[80:83]
    ds_read_b64_tr_b16 v[16:17], v9 offset:32768
    v_mul_f32 v52, v52, v60
    v_mul_f32 v53, v53, v61
    v_mul_f32 v54, v54, v62
    v_mul_f32 v55, v55, v63
    v_mfma_f32_16x16x32_bf16 v[84:87], v[24:27], v[140:143], v[84:87]
    ds_read_b64_tr_b16 v[18:19], v9 offset:33792
    s_mul_i32 s38, s81, 480
    s_add_u32 s38, s38, s82
    s_lshl_b32 s38, s38, 11
    s_lshl_b32 s39, s30, 8
    s_add_u32 s38, s38, s39
    s_add_u32 s39, s38, 8192
    v_and_b32 v2, 31, v0
    v_lshrrev_b32 v3, 5, v0
    v_lshlrev_b32 v11, 3, v2
    v_lshl_add_u32 v12, v3, 12, v11
    s_waitcnt lgkmcnt(10)
    v_mfma_f32_16x16x32_bf16 v[88:91], v[28:31], v[136:139], v[88:91]
    ds_read_b64_tr_b16 v[20:21], v9 offset:36864
    v_cvt_pk_bf16_f32 v56, v48, v49
    v_cvt_pk_bf16_f32 v57, v50, v51
    v_cvt_pk_bf16_f32 v58, v52, v53
    v_cvt_pk_bf16_f32 v59, v54, v55
    v_mfma_f32_16x16x32_bf16 v[92:95], v[28:31], v[140:143], v[92:95]
    ds_read_b64_tr_b16 v[22:23], v9 offset:37888
    buffer_load_dwordx2 v[96:97], v12, s[12:15], s38 offen sc1
    buffer_load_dwordx2 v[98:99], v12, s[12:15], s38 offen offset:2048 sc1
    s_waitcnt lgkmcnt(10)
    v_mfma_f32_16x16x32_bf16 v[80:83], v[32:35], v[144:147], v[80:83]
    ds_read_b64_tr_b16 v[24:25], v9 offset:34816
    v_permlane16_swap_b32 v56, v58
    v_permlane16_swap_b32 v57, v59
    buffer_store_dwordx4 v[56:59], v6, s[12:15], s47 offen offset:0 sc1
    v_mfma_f32_16x16x32_bf16 v[84:87], v[32:35], v[148:151], v[84:87]
    ds_read_b64_tr_b16 v[26:27], v9 offset:35840
    buffer_load_dwordx2 v[100:101], v11, s[12:15], s39 offen sc1
    s_waitcnt lgkmcnt(10)
    v_mfma_f32_16x16x32_bf16 v[88:91], v[36:39], v[144:147], v[88:91]
    ds_read_b64_tr_b16 v[28:29], v9 offset:38912
    v_mul_f32 v72, v64, v72
    v_mul_f32 v64, 0xbfb8aa3b, v64
    v_mul_f32 v73, v65, v73
    v_mul_f32 v65, 0xbfb8aa3b, v65
    v_mul_f32 v74, v66, v74
    v_mul_f32 v66, 0xbfb8aa3b, v66
    v_mul_f32 v75, v67, v75
    v_mul_f32 v67, 0xbfb8aa3b, v67
    v_mfma_f32_16x16x32_bf16 v[92:95], v[36:39], v[148:151], v[92:95]
    ds_read_b64_tr_b16 v[30:31], v9 offset:39936
    v_mov_b32 v104, 0x3f803f80
    v_mov_b32 v105, 0x3f803f80
    s_lshl_b32 s38, s30, 9
    v_lshl_add_u32 v11, v0, 3, s38
    ds_write_b64 v11, v[104:105] offset:41280
    v_mov_b32 v103, 0
    v_lshlrev_b32 v11, 2, v0
    ds_write_b32 v11, v103 offset:45440
    s_waitcnt lgkmcnt(12)
    v_mfma_f32_16x16x32_bf16 v[80:83], v[40:43], v[152:155], v[80:83]
    ds_read_b64_tr_b16 v[32:33], v9 offset:40960
    v_mul_f32 v76, v68, v76
    v_mul_f32 v68, 0xbfb8aa3b, v68
    v_mul_f32 v77, v69, v77
    v_mul_f32 v69, 0xbfb8aa3b, v69
    v_mul_f32 v78, v70, v78
    v_mul_f32 v70, 0xbfb8aa3b, v70
    v_mul_f32 v79, v71, v79
    v_mul_f32 v71, 0xbfb8aa3b, v71
    v_mfma_f32_16x16x32_bf16 v[84:87], v[40:43], v[156:159], v[84:87]
    ds_read_b64_tr_b16 v[34:35], v9 offset:41984
    s_waitcnt lgkmcnt(12)
    v_mfma_f32_16x16x32_bf16 v[88:91], v[44:47], v[152:155], v[88:91]
    ds_read_b64_tr_b16 v[36:37], v9 offset:45056
    v_exp_f32 v64, v64
    v_exp_f32 v65, v65
    v_exp_f32 v66, v66
    v_exp_f32 v67, v67
    v_mfma_f32_16x16x32_bf16 v[92:95], v[44:47], v[156:159], v[92:95]
    ds_read_b64_tr_b16 v[38:39], v9 offset:46080
    s_waitcnt lgkmcnt(12)
    v_mfma_f32_16x16x32_bf16 v[80:83], v[16:19], v[160:163], v[80:83]
    ds_read_b64_tr_b16 v[40:41], v9 offset:43008
    v_exp_f32 v68, v68
    v_exp_f32 v69, v69
    v_exp_f32 v70, v70
    v_exp_f32 v71, v71
    v_mfma_f32_16x16x32_bf16 v[84:87], v[16:19], v[164:167], v[84:87]
    ds_read_b64_tr_b16 v[42:43], v9 offset:44032
    s_waitcnt lgkmcnt(12)
    v_mfma_f32_16x16x32_bf16 v[88:91], v[20:23], v[160:163], v[88:91]
    ds_read_b64_tr_b16 v[44:45], v9 offset:47104
    v_add_f32 v64, 1.0, v64
    v_add_f32 v65, 1.0, v65
    v_add_f32 v66, 1.0, v66
    v_add_f32 v67, 1.0, v67
    v_mfma_f32_16x16x32_bf16 v[92:95], v[20:23], v[164:167], v[92:95]
    ds_read_b64_tr_b16 v[46:47], v9 offset:48128
    s_waitcnt vmcnt(11)
    s_barrier
    s_waitcnt lgkmcnt(12)
    v_mfma_f32_16x16x32_bf16 v[80:83], v[24:27], v[168:171], v[80:83]
    ds_read_b64_tr_b16 v[16:17], v9 offset:49152
    v_add_f32 v68, 1.0, v68
    v_add_f32 v69, 1.0, v69
    v_add_f32 v70, 1.0, v70
    v_add_f32 v71, 1.0, v71
    v_mfma_f32_16x16x32_bf16 v[84:87], v[24:27], v[172:175], v[84:87]
    ds_read_b64_tr_b16 v[18:19], v9 offset:50176
    s_waitcnt lgkmcnt(12)
    v_mfma_f32_16x16x32_bf16 v[88:91], v[28:31], v[168:171], v[88:91]
    ds_read_b64_tr_b16 v[20:21], v9 offset:53248
    v_rcp_f32 v64, v64
    v_rcp_f32 v65, v65
    v_rcp_f32 v66, v66
    v_rcp_f32 v67, v67
    v_mfma_f32_16x16x32_bf16 v[92:95], v[28:31], v[172:175], v[92:95]
    ds_read_b64_tr_b16 v[22:23], v9 offset:54272
    s_waitcnt lgkmcnt(10)
    v_mfma_f32_16x16x32_bf16 v[80:83], v[32:35], v[176:179], v[80:83]
    ds_read_b64_tr_b16 v[24:25], v9 offset:51200
    v_rcp_f32 v68, v68
    v_rcp_f32 v69, v69
    v_rcp_f32 v70, v70
    v_rcp_f32 v71, v71
    v_mfma_f32_16x16x32_bf16 v[84:87], v[32:35], v[180:183], v[84:87]
    ds_read_b64_tr_b16 v[26:27], v9 offset:52224
    s_waitcnt lgkmcnt(10)
    v_mfma_f32_16x16x32_bf16 v[88:91], v[36:39], v[176:179], v[88:91]
    ds_read_b64_tr_b16 v[28:29], v9 offset:55296
    v_mul_f32 v64, v64, v72
    v_mul_f32 v65, v65, v73
    v_mul_f32 v66, v66, v74
    v_mul_f32 v67, v67, v75
    v_mfma_f32_16x16x32_bf16 v[92:95], v[36:39], v[180:183], v[92:95]
    ds_read_b64_tr_b16 v[30:31], v9 offset:56320
    s_waitcnt lgkmcnt(10)
    v_mfma_f32_16x16x32_bf16 v[80:83], v[40:43], v[184:187], v[80:83]
    ds_read_b64_tr_b16 v[32:33], v9 offset:57344
    v_mul_f32 v68, v68, v76
    v_mul_f32 v69, v69, v77
    v_mul_f32 v70, v70, v78
    v_mul_f32 v71, v71, v79
    v_mfma_f32_16x16x32_bf16 v[84:87], v[40:43], v[188:191], v[84:87]
    ds_read_b64_tr_b16 v[34:35], v9 offset:58368
    s_waitcnt lgkmcnt(10)
    v_mfma_f32_16x16x32_bf16 v[88:91], v[44:47], v[184:187], v[88:91]
    ds_read_b64_tr_b16 v[36:37], v9 offset:61440
    v_cvt_pk_bf16_f32 v72, v64, v65
    v_cvt_pk_bf16_f32 v73, v66, v67
    v_cvt_pk_bf16_f32 v74, v68, v69
    v_cvt_pk_bf16_f32 v75, v70, v71
    v_mfma_f32_16x16x32_bf16 v[92:95], v[44:47], v[188:191], v[92:95]
    ds_read_b64_tr_b16 v[38:39], v9 offset:62464
    s_waitcnt lgkmcnt(10)
    v_mfma_f32_16x16x32_bf16 v[80:83], v[16:19], v[192:195], v[80:83]
    ds_read_b64_tr_b16 v[40:41], v9 offset:59392
    v_permlane16_swap_b32 v72, v74
    v_permlane16_swap_b32 v73, v75
    buffer_store_dwordx4 v[72:75], v6, s[12:15], s47 offen offset:2048 sc1
    v_mfma_f32_16x16x32_bf16 v[84:87], v[16:19], v[196:199], v[84:87]
    ds_read_b64_tr_b16 v[42:43], v9 offset:60416
    s_waitcnt lgkmcnt(10)
    v_mfma_f32_16x16x32_bf16 v[88:91], v[20:23], v[192:195], v[88:91]
    ds_read_b64_tr_b16 v[44:45], v9 offset:63488
    v_and_b32 v11, 19, v2
    v_and_b32 v12, 4, v2
    v_lshl_add_u32 v11, v12, 1, v11
    v_and_b32 v12, 8, v2
    v_lshrrev_b32 v12, 1, v12
    v_add_u32 v11, v12, v11
    v_mfma_f32_16x16x32_bf16 v[92:95], v[20:23], v[196:199], v[92:95]
    ds_read_b64_tr_b16 v[46:47], v9 offset:64512
    s_waitcnt vmcnt(10)
    s_barrier
    v_add_u32 v9, 0x10000, v9
    s_waitcnt lgkmcnt(10)
    v_mfma_f32_16x16x32_bf16 v[80:83], v[24:27], v[200:203], v[80:83]
    ds_read_b64_tr_b16 v[16:17], v9 offset:0
    s_lshl_b32 s41, s30, 8
    v_lshl_add_u32 v11, v11, 3, s41
    v_add_u32 v8, 16512, v11
    v_mul_u32_u24 v12, 8256, v3
    v_add_u32 v7, v12, v11
    v_mfma_f32_16x16x32_bf16 v[84:87], v[24:27], v[204:207], v[84:87]
    ds_read_b64_tr_b16 v[18:19], v9 offset:1024
    s_waitcnt lgkmcnt(10)
    v_mfma_f32_16x16x32_bf16 v[88:91], v[28:31], v[200:203], v[88:91]
    ds_read_b64_tr_b16 v[20:21], v9 offset:4096
    v_and_b32 v11, 1, v14
    v_and_b32 v12, 3, v0
    v_lshl_add_u32 v11, v11, 2, v12
    v_min_u32 v11, 5, v11
    v_add_u32 v11, 5, v11
    v_mul_u32_u24 v11, 4128, v11
    v_mfma_f32_16x16x32_bf16 v[92:95], v[28:31], v[204:207], v[92:95]
    ds_read_b64_tr_b16 v[22:23], v9 offset:5120
    s_waitcnt lgkmcnt(10)
    v_mfma_f32_16x16x32_bf16 v[80:83], v[32:35], v[208:211], v[80:83]
    ds_read_b64_tr_b16 v[24:25], v9 offset:2048
    v_bfe_u32 v12, v0, 2, 2
    v_lshl_add_u32 v12, v3, 3, v12
    v_lshl_add_u32 v12, v12, 3, s41
    v_add_u32 v10, v11, v12
    v_lshlrev_b32 v11, 3, v3
    v_sub_u32 v11, v2, v11
    v_mfma_f32_16x16x32_bf16 v[84:87], v[32:35], v[212:215], v[84:87]
    ds_read_b64_tr_b16 v[26:27], v9 offset:3072
    s_waitcnt lgkmcnt(10)
    v_mfma_f32_16x16x32_bf16 v[88:91], v[36:39], v[208:211], v[88:91]
    ds_read_b64_tr_b16 v[28:29], v9 offset:6144
    v_mov_b32 v12, 0xffff
    v_mov_b32 v102, 0xffff0000
    s_mov_b32 s8, s56
    s_mov_b32 s9, s57
    s_mov_b32 s10, 2621440
    s_lshr_b32 s86, s24, 1
    s_lshl_b32 s86, s86, 3
    s_and_b32 s87, s25, 7
    s_add_u32 s86, s86, s87
    s_and_b32 s87, s24, 1
    s_lshl_b32 s87, s87, 2
    s_add_u32 s87, s87, s28
    s_mul_i32 s76, s87, 68
    s_add_u32 s76, s76, s34
    s_mul_i32 s76, s76, 5120
    s_add_u32 s76, s76, 18874368
    s_mul_i32 s77, s34, 25600
    s_add_u32 s77, s77, 61440
    v_mfma_f32_16x16x32_bf16 v[92:95], v[36:39], v[212:215], v[92:95]
    ds_read_b64_tr_b16 v[30:31], v9 offset:7168
    s_waitcnt lgkmcnt(10)
    v_mfma_f32_16x16x32_bf16 v[80:83], v[40:43], v[216:219], v[80:83]
    ds_read_b64_tr_b16 v[32:33], v9 offset:8192
    v_cmp_le_i32 s[44:45], 0, v11
    v_cmp_le_i32 s[46:47], 1, v11
    v_cmp_le_i32 s[48:49], 2, v11
    v_cmp_le_i32 s[50:51], 3, v11
    v_mfma_f32_16x16x32_bf16 v[84:87], v[40:43], v[220:223], v[84:87]
    ds_read_b64_tr_b16 v[34:35], v9 offset:9216
    s_waitcnt lgkmcnt(10)
    v_mfma_f32_16x16x32_bf16 v[88:91], v[44:47], v[216:219], v[88:91]
    ds_read_b64_tr_b16 v[36:37], v9 offset:12288
    v_cmp_le_i32 s[52:53], 4, v11
    v_cmp_le_i32 s[54:55], 5, v11
    v_cmp_le_i32 s[56:57], 6, v11
    v_cmp_le_i32 s[58:59], 7, v11
    v_mfma_f32_16x16x32_bf16 v[92:95], v[44:47], v[220:223], v[92:95]
    ds_read_b64_tr_b16 v[38:39], v9 offset:13312
    s_waitcnt lgkmcnt(10)
    v_mfma_f32_16x16x32_bf16 v[80:83], v[16:19], v[224:227], v[80:83]
    ds_read_b64_tr_b16 v[40:41], v9 offset:10240
    v_cmp_le_i32 s[60:61], 16, v11
    v_cmp_le_i32 s[62:63], 17, v11
    v_cmp_le_i32 s[64:65], 18, v11
    v_cmp_le_i32 s[66:67], 19, v11
    v_mfma_f32_16x16x32_bf16 v[84:87], v[16:19], v[228:231], v[84:87]
    ds_read_b64_tr_b16 v[42:43], v9 offset:11264
    s_waitcnt lgkmcnt(10)
    v_mfma_f32_16x16x32_bf16 v[88:91], v[20:23], v[224:227], v[88:91]
    ds_read_b64_tr_b16 v[44:45], v9 offset:14336
    v_cmp_le_i32 s[68:69], 20, v11
    v_cmp_le_i32 s[70:71], 21, v11
    v_cmp_le_i32 s[72:73], 22, v11
    v_cmp_le_i32 s[74:75], 23, v11
    v_mfma_f32_16x16x32_bf16 v[92:95], v[20:23], v[228:231], v[92:95]
    ds_read_b64_tr_b16 v[46:47], v9 offset:15360
    s_waitcnt lgkmcnt(10)
    v_mfma_f32_16x16x32_bf16 v[80:83], v[24:27], v[232:235], v[80:83]
    v_cndmask_b32 v104, 0, v12, s[44:45]
    v_cndmask_b32 v103, 0, v102, s[46:47]
    v_or_b32 v104, v104, v103
    v_mfma_f32_16x16x32_bf16 v[84:87], v[24:27], v[236:239], v[84:87]
    s_waitcnt lgkmcnt(8)
    v_mfma_f32_16x16x32_bf16 v[88:91], v[28:31], v[232:235], v[88:91]
    v_cndmask_b32 v105, 0, v12, s[48:49]
    v_cndmask_b32 v103, 0, v102, s[50:51]
    v_or_b32 v105, v105, v103
    v_mfma_f32_16x16x32_bf16 v[92:95], v[28:31], v[236:239], v[92:95]
    s_waitcnt lgkmcnt(6)
    v_mfma_f32_16x16x32_bf16 v[80:83], v[32:35], v[240:243], v[80:83]
    v_cndmask_b32 v106, 0, v12, s[52:53]
    v_cndmask_b32 v103, 0, v102, s[54:55]
    v_or_b32 v106, v106, v103
    v_mfma_f32_16x16x32_bf16 v[84:87], v[32:35], v[244:247], v[84:87]
    s_waitcnt lgkmcnt(4)
    v_mfma_f32_16x16x32_bf16 v[88:91], v[36:39], v[240:243], v[88:91]
    v_cndmask_b32 v107, 0, v12, s[56:57]
    v_cndmask_b32 v103, 0, v102, s[58:59]
    v_or_b32 v107, v107, v103
    v_mfma_f32_16x16x32_bf16 v[92:95], v[36:39], v[244:247], v[92:95]
    s_waitcnt lgkmcnt(2)
    v_mfma_f32_16x16x32_bf16 v[80:83], v[40:43], v[248:251], v[80:83]
    v_cndmask_b32 v108, 0, v12, s[60:61]
    v_cndmask_b32 v103, 0, v102, s[62:63]
    v_or_b32 v108, v108, v103
    v_mfma_f32_16x16x32_bf16 v[84:87], v[40:43], v[252:255], v[84:87]
    s_waitcnt lgkmcnt(0)
    v_mfma_f32_16x16x32_bf16 v[88:91], v[44:47], v[248:251], v[88:91]
    v_cndmask_b32 v109, 0, v12, s[64:65]
    v_cndmask_b32 v103, 0, v102, s[66:67]
    v_or_b32 v109, v109, v103
    v_mfma_f32_16x16x32_bf16 v[92:95], v[44:47], v[252:255], v[92:95]
    v_cndmask_b32 v110, 0, v12, s[68:69]
    v_cndmask_b32 v103, 0, v102, s[70:71]
    v_or_b32 v110, v110, v103
    v_cndmask_b32 v111, 0, v12, s[72:73]
    v_cndmask_b32 v103, 0, v102, s[74:75]
    v_or_b32 v111, v111, v103
    s_waitcnt vmcnt(1)
    s_waitcnt lgkmcnt(0)
    s_barrier
    s_setprio 2
    ds_read_b64 v[16:17], v7 offset:2048
    ds_read_b64 v[18:19], v7 offset:6176
    ds_read_b64 v[20:21], v8 offset:2048
    ds_read_b64 v[22:23], v7 offset:0
    ds_read_b64 v[24:25], v7 offset:4128
    ds_read_b64 v[26:27], v8 offset:0
    ds_read_b64 v[28:29], v7 offset:256
    ds_read_b64 v[30:31], v7 offset:4384
    ds_read_b64 v[32:33], v8 offset:256
    ds_read_b64 v[34:35], v7 offset:512
    ds_read_b64 v[36:37], v7 offset:4640
    ds_read_b64 v[38:39], v8 offset:512
    v_mul_f32 v88, v80, v88
    v_mul_f32 v80, 0xbfb8aa3b, v80
    v_mul_f32 v89, v81, v89
    v_mul_f32 v81, 0xbfb8aa3b, v81
    v_mul_f32 v90, v82, v90
    v_mul_f32 v82, 0xbfb8aa3b, v82
    v_mul_f32 v91, v83, v91
    v_mul_f32 v83, 0xbfb8aa3b, v83
    v_mul_f32 v92, v84, v92
    v_mul_f32 v84, 0xbfb8aa3b, v84
    v_mul_f32 v93, v85, v93
    v_mul_f32 v85, 0xbfb8aa3b, v85
    v_mul_f32 v94, v86, v94
    v_mul_f32 v86, 0xbfb8aa3b, v86
    v_mul_f32 v95, v87, v95
    v_mul_f32 v87, 0xbfb8aa3b, v87
    v_exp_f32 v80, v80
    v_exp_f32 v81, v81
    v_exp_f32 v82, v82
    v_exp_f32 v83, v83
    v_exp_f32 v84, v84
    v_exp_f32 v85, v85
    v_exp_f32 v86, v86
    v_exp_f32 v87, v87
    v_add_f32 v80, 1.0, v80
    v_add_f32 v81, 1.0, v81
    v_add_f32 v82, 1.0, v82
    v_add_f32 v83, 1.0, v83
    v_add_f32 v84, 1.0, v84
    v_add_f32 v85, 1.0, v85
    v_add_f32 v86, 1.0, v86
    v_add_f32 v87, 1.0, v87
    v_rcp_f32 v80, v80
    v_rcp_f32 v81, v81
    v_rcp_f32 v82, v82
    v_rcp_f32 v83, v83
    v_rcp_f32 v84, v84
    v_rcp_f32 v85, v85
    v_rcp_f32 v86, v86
    v_rcp_f32 v87, v87
    v_mul_f32 v80, v80, v88
    v_mul_f32 v81, v81, v89
    v_mul_f32 v82, v82, v90
    v_mul_f32 v83, v83, v91
    v_mul_f32 v84, v84, v92
    v_mul_f32 v85, v85, v93
    v_mul_f32 v86, v86, v94
    v_mul_f32 v87, v87, v95
    v_cvt_pk_bf16_f32 v88, v80, v81
    v_cvt_pk_bf16_f32 v89, v82, v83
    v_cvt_pk_bf16_f32 v90, v84, v85
    v_cvt_pk_bf16_f32 v91, v86, v87
    s_nop 0
    v_permlane16_swap_b32 v88, v90
    v_permlane16_swap_b32 v89, v91
    buffer_store_dwordx4 v[88:91], v6, s[12:15], s29 offen offset:0 sc1
    v_cmp_eq_u32 vcc, 0, v3
    v_mov_b32 v9, 0xff800000
    s_mov_b32 s26, s86
    s_mov_b32 s27, s87
    s_mov_b32 s36, s76
    s_mov_b32 s37, s77
    v_cndmask_b32 v100, 0, v100, vcc
    v_cndmask_b32 v101, 0, v101, vcc
    s_mov_b32 s79, 22087680
    s_lshl_b32 s78, s81, 3
    s_add_u32 s78, s78, s30
    s_lshl_b32 s40, s81, 2
    s_add_u32 s40, s40, s31
    s_mul_i32 s40, s40, 278528
    s_add_u32 s40, s40, 8585216
    s_lshl_b32 s41, s32, 9
    s_add_u32 s40, s40, s41
    s_lshl_b32 s41, s80, 11
    s_add_u32 s41, s41, s40
    s_lshl_b32 s38, s80, 9
    s_add_u32 s40, s40, s38
    s_lshl_b32 s38, s32, 8
    s_sub_u32 s40, s40, s38
    s_add_u32 s40, s40, 65536
    s_waitcnt vmcnt(1)
    v_mov_b32 v12, 1
    s_mov_b64 exec, 1
    buffer_store_dword v12, off, s[12:15], s84 sc1
    s_mov_b64 exec, -1
    s_cmp_lt_u32 s30, 4
    s_cbranch_scc1 ATT_A
    s_setprio 1
    ds_read_b64 v[40:41], v7 offset:768
    ds_read_b64 v[42:43], v7 offset:4896
    ds_read_b64 v[44:45], v8 offset:768
    s_waitcnt lgkmcnt(12)
    v_mfma_f32_32x32x16_bf16 v[240:255], v[16:19], v[96:99], 0
    v_mfma_f32_32x32x8_bf16 v[240:255], v[20:21], v[100:101], v[240:255]
    ds_read_b64 v[46:47], v7 offset:1024
    ds_read_b64 v[48:49], v7 offset:5152
    ds_read_b64 v[50:51], v8 offset:1024
    s_waitcnt lgkmcnt(12)
    v_mfma_f32_32x32x16_bf16 v[112:127], v[22:25], v[96:99], 0
    v_mfma_f32_32x32x8_bf16 v[112:127], v[26:27], v[100:101], v[112:127]
    ds_read_b64 v[52:53], v7 offset:1280
    ds_read_b64 v[54:55], v7 offset:5408
    ds_read_b64 v[56:57], v8 offset:1280
    s_waitcnt lgkmcnt(12)
    v_mfma_f32_32x32x16_bf16 v[128:143], v[28:31], v[96:99], 0
    v_mfma_f32_32x32x8_bf16 v[128:143], v[32:33], v[100:101], v[128:143]
    ds_read_b64 v[58:59], v7 offset:1536
    ds_read_b64 v[60:61], v7 offset:5664
    ds_read_b64 v[62:63], v8 offset:1536
    s_waitcnt lgkmcnt(12)
    v_mfma_f32_32x32x16_bf16 v[144:159], v[34:37], v[96:99], 0
    s_cmp_lt_u32 s78, 8
    s_cbranch_scc1 FIXB0
NOFIXB0:
    v_cndmask_b32 v240, v112, v240, s[44:45]
    v_cndmask_b32 v241, v113, v241, s[46:47]
    v_cndmask_b32 v242, v114, v242, s[48:49]
    v_cndmask_b32 v243, v115, v243, s[50:51]
    v_cndmask_b32 v244, v116, v244, s[52:53]
    v_cndmask_b32 v245, v117, v245, s[54:55]
    v_cndmask_b32 v246, v118, v246, s[56:57]
    v_mfma_f32_32x32x8_bf16 v[144:159], v[38:39], v[100:101], v[144:159]
    v_cndmask_b32 v247, v119, v247, s[58:59]
    v_cndmask_b32 v248, v120, v248, s[60:61]
    v_cndmask_b32 v249, v121, v249, s[62:63]
    v_cndmask_b32 v250, v122, v250, s[64:65]
    v_cndmask_b32 v251, v123, v251, s[66:67]
    v_cndmask_b32 v252, v124, v252, s[68:69]
    v_cndmask_b32 v253, v125, v253, s[70:71]
    v_cndmask_b32 v254, v126, v254, s[72:73]
    v_cndmask_b32 v255, v127, v255, s[74:75]
    ds_read_b64 v[64:65], v7 offset:1792
    ds_read_b64 v[66:67], v7 offset:5920
    ds_read_b64 v[68:69], v8 offset:1792
    s_waitcnt lgkmcnt(12)
    v_lshlrev_b32 v92, 4, v0
    buffer_load_dwordx4 v[88:91], v92, s[12:15], s79 offen sc1
    v_mfma_f32_32x32x16_bf16 v[160:175], v[40:43], v[96:99], 0
    v_max_f32 v112, v240, v241
    v_max_f32 v113, v242, v243
    v_max_f32 v114, v244, v245
    v_max_f32 v115, v246, v247
    v_max3_f32 v112, v248, v249, v112
    v_max3_f32 v113, v250, v251, v113
    v_max3_f32 v114, v252, v253, v114
    v_max3_f32 v115, v254, v255, v115
    v_mfma_f32_32x32x8_bf16 v[160:175], v[44:45], v[100:101], v[160:175]
    s_cmp_lt_u32 s78, 7
    s_cbranch_scc1 FIXB1
NOFIXB1:
    v_max3_f32 v112, v128, v129, v112
    v_max3_f32 v113, v130, v131, v113
    v_max3_f32 v114, v132, v133, v114
    v_max3_f32 v115, v134, v135, v115
    v_max3_f32 v112, v136, v137, v112
    v_max3_f32 v113, v138, v139, v113
    v_max3_f32 v114, v140, v141, v114
    v_max3_f32 v115, v142, v143, v115
    s_waitcnt lgkmcnt(9)
    v_mfma_f32_32x32x16_bf16 v[176:191], v[46:49], v[96:99], 0
    s_cmp_lt_u32 s78, 6
    s_cbranch_scc1 FIXB2
NOFIXB2:
    v_max3_f32 v112, v144, v145, v112
    v_max3_f32 v113, v146, v147, v113
    v_max3_f32 v114, v148, v149, v114
    v_mfma_f32_32x32x8_bf16 v[176:191], v[50:51], v[100:101], v[176:191]
    v_max3_f32 v115, v150, v151, v115
    v_max3_f32 v112, v152, v153, v112
    v_max3_f32 v113, v154, v155, v113
    v_max3_f32 v114, v156, v157, v114
    v_max3_f32 v115, v158, v159, v115
    s_waitcnt lgkmcnt(6)
    v_mfma_f32_32x32x16_bf16 v[192:207], v[52:55], v[96:99], 0
    s_cmp_lt_u32 s78, 5
    s_cbranch_scc1 FIXB3
NOFIXB3:
    v_max3_f32 v112, v160, v161, v112
    v_max3_f32 v113, v162, v163, v113
    v_max3_f32 v114, v164, v165, v114
    v_mfma_f32_32x32x8_bf16 v[192:207], v[56:57], v[100:101], v[192:207]
    v_max3_f32 v115, v166, v167, v115
    v_max3_f32 v112, v168, v169, v112
    v_max3_f32 v113, v170, v171, v113
    v_max3_f32 v114, v172, v173, v114
    v_max3_f32 v115, v174, v175, v115
    s_waitcnt lgkmcnt(3)
    v_mfma_f32_32x32x16_bf16 v[208:223], v[58:61], v[96:99], 0
    s_cmp_lt_u32 s78, 4
    s_cbranch_scc1 FIXB4
NOFIXB4:
    v_max3_f32 v112, v176, v177, v112
    v_max3_f32 v113, v178, v179, v113
    v_max3_f32 v114, v180, v181, v114
    v_mfma_f32_32x32x8_bf16 v[208:223], v[62:63], v[100:101], v[208:223]
    v_max3_f32 v115, v182, v183, v115
    v_max3_f32 v112, v184, v185, v112
    v_max3_f32 v113, v186, v187, v113
    v_max3_f32 v114, v188, v189, v114
    v_max3_f32 v115, v190, v191, v115
    s_waitcnt lgkmcnt(0)
    v_mfma_f32_32x32x16_bf16 v[224:239], v[64:67], v[96:99], 0
    s_cmp_lt_u32 s78, 3
    s_cbranch_scc1 FIXB5
NOFIXB5:
    v_max3_f32 v112, v192, v193, v112
    v_max3_f32 v113, v194, v195, v113
    v_max3_f32 v114, v196, v197, v114
    v_mfma_f32_32x32x8_bf16 v[224:239], v[68:69], v[100:101], v[224:239]
    v_max3_f32 v115, v198, v199, v115
    v_max3_f32 v112, v200, v201, v112
    v_max3_f32 v113, v202, v203, v113
    v_max3_f32 v114, v204, v205, v114
    v_max3_f32 v115, v206, v207, v115
    ds_read_b64_tr_b16 v[80:81], v10 offset:2048
    ds_read_b64_tr_b16 v[82:83], v10 offset:2080
    ds_read_b64_tr_b16 v[84:85], v10 offset:2176
    ds_read_b64_tr_b16 v[86:87], v10 offset:2208
    ds_read_b64_tr_b16 v[16:17], v10 offset:0
    ds_read_b64_tr_b16 v[18:19], v10 offset:32
    ds_read_b64_tr_b16 v[20:21], v10 offset:128
    ds_read_b64_tr_b16 v[22:23], v10 offset:160
    ds_read_b64_tr_b16 v[24:25], v10 offset:256
    ds_read_b64_tr_b16 v[26:27], v10 offset:288
    ds_read_b64_tr_b16 v[28:29], v10 offset:384
    ds_read_b64_tr_b16 v[30:31], v10 offset:416
    s_cmp_lt_u32 s78, 2
    s_cbranch_scc1 FIXB6
NOFIXB6:
    s_branch PN3
.p2align 12
PG3:
    s_branch WARMED
PN3:
    v_max3_f32 v112, v208, v209, v112
    v_max3_f32 v113, v210, v211, v113
    v_max3_f32 v114, v212, v213, v114
    v_max3_f32 v115, v214, v215, v115
    v_max3_f32 v112, v216, v217, v112
    v_max3_f32 v113, v218, v219, v113
    v_max3_f32 v114, v220, v221, v114
    v_max3_f32 v115, v222, v223, v115
    s_cmp_lt_u32 s78, 1
    s_cbranch_scc1 FIXB7
NOFIXB7:
    v_max3_f32 v112, v224, v225, v112
    v_max3_f32 v113, v226, v227, v113
    v_max3_f32 v114, v228, v229, v114
    v_max3_f32 v115, v230, v231, v115
    v_max3_f32 v112, v232, v233, v112
    v_max3_f32 v113, v234, v235, v113
    v_max3_f32 v114, v236, v237, v114
    v_max3_f32 v115, v238, v239, v115
    v_max3_f32 v112, v112, v113, v114
    v_max_f32 v112, v112, v115
    v_mov_b32 v113, v112
    s_mov_b32 s42, 0x3ea52b5c
    s_mov_b32 s43, 0x3ea52b5c
    v_permlane32_swap_b32 v112, v113
    v_max_f32 v112, v112, v113
    v_mul_f32 v8, 0xbea52b5c, v112
    s_waitcnt vmcnt(0)
    s_mov_b32 s88, 0
SPIN2:
    v_and_b32 v88, v88, v89
    v_and_b32 v88, v88, v90
    v_and_b32 v88, v88, v91
    v_cmp_gt_u32 vcc, 1, v88
    s_add_u32 s88, s88, 1
    s_nop 0
    s_and_b64 vcc, vcc, -1
    s_cbranch_scc0 GO2
    s_cmp_gt_u32 s88, 0x20000
    s_cbranch_scc1 GO2
    s_sleep 8
    v_lshlrev_b32 v92, 4, v0
    buffer_load_dwordx4 v[88:91], v92, s[12:15], s79 offen sc1
    s_waitcnt vmcnt(0)
    s_branch SPIN2
GO2:
    s_lshl_b32 s38, s81, 10
    s_lshl_b32 s39, s30, 7
    s_add_u32 s38, s38, s39
    s_add_u32 s38, s38, 22020096
    v_lshlrev_b32 v88, 2, v2
    buffer_load_dword v4, v88, s[12:15], s38 offen sc1
    v_mov_b32 v12, 1
    s_mov_b64 exec, 1
    buffer_store_dword v12, off, s[12:15], s3 sc1
    s_mov_b64 exec, -1
    s_add_u32 m0, s37, 0
    s_add_u32 s39, s36, 245760
    buffer_load_dwordx4 v1, s[12:15], s39 offen sc1 lds
    s_add_u32 m0, s37, 1024
    s_add_u32 s39, s36, 246784
    buffer_load_dwordx4 v1, s[12:15], s39 offen sc1 lds
    s_add_u32 m0, s37, 2048
    s_add_u32 s39, s36, 247808
    buffer_load_dwordx4 v1, s[12:15], s39 offen sc1 lds
    s_add_u32 m0, s37, 3072
    s_add_u32 s39, s36, 248832
    buffer_load_dwordx4 v1, s[12:15], s39 offen sc1 lds
    s_add_u32 m0, s37, 4096
    s_add_u32 s39, s36, 249856
    buffer_load_dwordx4 v1, s[12:15], s39 offen sc1 lds
    s_add_u32 m0, s37, 5120
    s_add_u32 s39, s36, 266240
    buffer_load_dwordx4 v1, s[12:15], s39 offen sc1 lds
    s_add_u32 m0, s37, 6144
    s_add_u32 s39, s36, 267264
    buffer_load_dwordx4 v1, s[12:15], s39 offen sc1 lds
    s_add_u32 m0, s37, 7168
    s_add_u32 s39, s36, 268288
    buffer_load_dwordx4 v1, s[12:15], s39 offen sc1 lds
    s_add_u32 m0, s37, 8192
    s_add_u32 s39, s36, 269312
    buffer_load_dwordx4 v1, s[12:15], s39 offen sc1 lds
    s_add_u32 m0, s37, 9216
    s_add_u32 s39, s36, 270336
    buffer_load_dwordx4 v1, s[12:15], s39 offen sc1 lds
    s_add_u32 m0, s37, 10240
    s_add_u32 s39, s36, 286720
    buffer_load_dwordx4 v1, s[12:15], s39 offen sc1 lds
    s_add_u32 m0, s37, 11264
    s_add_u32 s39, s36, 287744
    buffer_load_dwordx4 v1, s[12:15], s39 offen sc1 lds
    s_add_u32 m0, s37, 12288
    s_add_u32 s39, s36, 288768
    buffer_load_dwordx4 v1, s[12:15], s39 offen sc1 lds
    s_add_u32 m0, s37, 13312
    s_add_u32 s39, s36, 289792
    buffer_load_dwordx4 v1, s[12:15], s39 offen sc1 lds
    s_add_u32 m0, s37, 14336
    s_add_u32 s39, s36, 290816
    buffer_load_dwordx4 v1, s[12:15], s39 offen sc1 lds
    s_add_u32 m0, s37, 15360
    s_add_u32 s39, s36, 307200
    buffer_load_dwordx4 v1, s[12:15], s39 offen sc1 lds
    s_add_u32 m0, s37, 16384
    s_add_u32 s39, s36, 308224
    buffer_load_dwordx4 v1, s[12:15], s39 offen sc1 lds
    s_add_u32 m0, s37, 17408
    s_add_u32 s39, s36, 309248
    buffer_load_dwordx4 v1, s[12:15], s39 offen sc1 lds
    s_add_u32 m0, s37, 18432
    s_add_u32 s39, s36, 310272
    buffer_load_dwordx4 v1, s[12:15], s39 offen sc1 lds
    s_add_u32 m0, s37, 19456
    s_add_u32 s39, s36, 311296
    buffer_load_dwordx4 v1, s[12:15], s39 offen sc1 lds
    s_add_u32 m0, s37, 20480
    s_add_u32 s39, s36, 327680
    buffer_load_dwordx4 v1, s[12:15], s39 offen sc1 lds
    s_add_u32 m0, s37, 21504
    s_add_u32 s39, s36, 328704
    buffer_load_dwordx4 v1, s[12:15], s39 offen sc1 lds
    s_add_u32 m0, s37, 22528
    s_add_u32 s39, s36, 329728
    buffer_load_dwordx4 v1, s[12:15], s39 offen sc1 lds
    s_add_u32 m0, s37, 23552
    s_add_u32 s39, s36, 330752
    buffer_load_dwordx4 v1, s[12:15], s39 offen sc1 lds
    s_add_u32 m0, s37, 24576
    s_add_u32 s39, s36, 331776
    buffer_load_dwordx4 v1, s[12:15], s39 offen sc1 lds
    v_pk_fma_f32 v[240:241], v[240:241], s[42:43], v[8:9] op_sel_hi:[1,1,0]
    ds_read_b64_tr_b16 v[32:33], v10 offset:512
    v_pk_fma_f32 v[242:243], v[242:243], s[42:43], v[8:9] op_sel_hi:[1,1,0]
    v_pk_fma_f32 v[244:245], v[244:245], s[42:43], v[8:9] op_sel_hi:[1,1,0]
    ds_read_b64_tr_b16 v[34:35], v10 offset:544
    v_pk_fma_f32 v[246:247], v[246:247], s[42:43], v[8:9] op_sel_hi:[1,1,0]
    v_pk_fma_f32 v[248:249], v[248:249], s[42:43], v[8:9] op_sel_hi:[1,1,0]
    ds_read_b64_tr_b16 v[36:37], v10 offset:640
    v_pk_fma_f32 v[250:251], v[250:251], s[42:43], v[8:9] op_sel_hi:[1,1,0]
    v_pk_fma_f32 v[252:253], v[252:253], s[42:43], v[8:9] op_sel_hi:[1,1,0]
    ds_read_b64_tr_b16 v[38:39], v10 offset:672
    v_pk_fma_f32 v[254:255], v[254:255], s[42:43], v[8:9] op_sel_hi:[1,1,0]
    v_exp_f32 v240, v240
    ds_read_b64_tr_b16 v[40:41], v10 offset:768
    v_exp_f32 v241, v241
    v_exp_f32 v242, v242
    ds_read_b64_tr_b16 v[42:43], v10 offset:800
    v_exp_f32 v243, v243
    v_exp_f32 v244, v244
    ds_read_b64_tr_b16 v[44:45], v10 offset:896
    v_exp_f32 v245, v245
    v_exp_f32 v246, v246
    ds_read_b64_tr_b16 v[46:47], v10 offset:928
    v_exp_f32 v247, v247
    v_exp_f32 v248, v248
    ds_read_b64_tr_b16 v[48:49], v10 offset:1024
    v_exp_f32 v249, v249
    v_exp_f32 v250, v250
    ds_read_b64_tr_b16 v[50:51], v10 offset:1056
    v_exp_f32 v251, v251
    v_exp_f32 v252, v252
    ds_read_b64_tr_b16 v[52:53], v10 offset:1152
    v_exp_f32 v253, v253
    v_exp_f32 v254, v254
    ds_read_b64_tr_b16 v[54:55], v10 offset:1184
    v_exp_f32 v255, v255
    v_cvt_pk_bf16_f32 v240, v240, v241
    v_cvt_pk_bf16_f32 v241, v242, v243
    v_cvt_pk_bf16_f32 v242, v244, v245
    v_cvt_pk_bf16_f32 v243, v246, v247
    v_cvt_pk_bf16_f32 v244, v248, v249
    v_cvt_pk_bf16_f32 v245, v250, v251
    v_cvt_pk_bf16_f32 v246, v252, v253
    v_cvt_pk_bf16_f32 v247, v254, v255
    v_bfi_b32 v112, v104, 0, v240
    v_and_b32 v240, v104, v240
    v_bfi_b32 v113, v105, 0, v241
    v_and_b32 v241, v105, v241
    v_bfi_b32 v114, v106, 0, v242
    v_and_b32 v242, v106, v242
    v_bfi_b32 v115, v107, 0, v243
    v_and_b32 v243, v107, v243
    v_bfi_b32 v116, v108, 0, v244
    v_and_b32 v244, v108, v244
    v_bfi_b32 v117, v109, 0, v245
    v_and_b32 v245, v109, v245
    v_bfi_b32 v118, v110, 0, v246
    v_and_b32 v246, v110, v246
    v_bfi_b32 v119, v111, 0, v247
    v_and_b32 v247, v111, v247
    s_waitcnt lgkmcnt(0)
    v_pk_fma_f32 v[128:129], v[128:129], s[42:43], v[8:9] op_sel_hi:[1,1,0]
    ds_read_b64_tr_b16 v[56:57], v10 offset:1280
    v_pk_fma_f32 v[130:131], v[130:131], s[42:43], v[8:9] op_sel_hi:[1,1,0]
    v_pk_fma_f32 v[132:133], v[132:133], s[42:43], v[8:9] op_sel_hi:[1,1,0]
    ds_read_b64_tr_b16 v[58:59], v10 offset:1312
    v_pk_fma_f32 v[134:135], v[134:135], s[42:43], v[8:9] op_sel_hi:[1,1,0]
    v_pk_fma_f32 v[136:137], v[136:137], s[42:43], v[8:9] op_sel_hi:[1,1,0]
    ds_read_b64_tr_b16 v[60:61], v10 offset:1408
    v_pk_fma_f32 v[138:139], v[138:139], s[42:43], v[8:9] op_sel_hi:[1,1,0]
    v_pk_fma_f32 v[140:141], v[140:141], s[42:43], v[8:9] op_sel_hi:[1,1,0]
    ds_read_b64_tr_b16 v[62:63], v10 offset:1440
    v_pk_fma_f32 v[142:143], v[142:143], s[42:43], v[8:9] op_sel_hi:[1,1,0]
    v_exp_f32 v128, v128
    ds_read_b64_tr_b16 v[64:65], v10 offset:1536
    v_exp_f32 v129, v129
    v_mfma_f32_32x32x16_bf16 v[96:111], v[80:83], v[240:243], 0
    ds_read_b64_tr_b16 v[66:67], v10 offset:1568
    v_exp_f32 v130, v130
    v_exp_f32 v131, v131
    ds_read_b64_tr_b16 v[68:69], v10 offset:1664
    v_exp_f32 v132, v132
    v_exp_f32 v133, v133
    ds_read_b64_tr_b16 v[70:71], v10 offset:1696
    v_mfma_f32_32x32x16_bf16 v[96:111], v[84:87], v[244:247], v[96:111]
    v_exp_f32 v134, v134
    ds_read_b64_tr_b16 v[72:73], v10 offset:1792
    v_exp_f32 v135, v135
    v_exp_f32 v136, v136
    ds_read_b64_tr_b16 v[74:75], v10 offset:1824
    v_exp_f32 v137, v137
    v_mfma_f32_32x32x16_bf16 v[96:111], v[16:19], v[112:115], v[96:111]
    ds_read_b64_tr_b16 v[76:77], v10 offset:1920
    v_exp_f32 v138, v138
    v_exp_f32 v139, v139
    ds_read_b64_tr_b16 v[78:79], v10 offset:1952
    v_exp_f32 v140, v140
    v_exp_f32 v141, v141
    v_mfma_f32_32x32x16_bf16 v[96:111], v[20:23], v[116:119], v[96:111]
    v_exp_f32 v142, v142
    v_exp_f32 v143, v143
    v_cvt_pk_bf16_f32 v128, v128, v129
    v_cvt_pk_bf16_f32 v129, v130, v131
    v_cvt_pk_bf16_f32 v130, v132, v133
    v_cvt_pk_bf16_f32 v131, v134, v135
    v_cvt_pk_bf16_f32 v132, v136, v137
    v_cvt_pk_bf16_f32 v133, v138, v139
    v_cvt_pk_bf16_f32 v134, v140, v141
    v_cvt_pk_bf16_f32 v135, v142, v143
    s_waitcnt lgkmcnt(0)
    v_pk_fma_f32 v[144:145], v[144:145], s[42:43], v[8:9] op_sel_hi:[1,1,0]
    v_pk_fma_f32 v[146:147], v[146:147], s[42:43], v[8:9] op_sel_hi:[1,1,0]
    v_pk_fma_f32 v[148:149], v[148:149], s[42:43], v[8:9] op_sel_hi:[1,1,0]
    v_pk_fma_f32 v[150:151], v[150:151], s[42:43], v[8:9] op_sel_hi:[1,1,0]
    v_pk_fma_f32 v[152:153], v[152:153], s[42:43], v[8:9] op_sel_hi:[1,1,0]
    v_pk_fma_f32 v[154:155], v[154:155], s[42:43], v[8:9] op_sel_hi:[1,1,0]
    v_pk_fma_f32 v[156:157], v[156:157], s[42:43], v[8:9] op_sel_hi:[1,1,0]
    v_pk_fma_f32 v[158:159], v[158:159], s[42:43], v[8:9] op_sel_hi:[1,1,0]
    v_exp_f32 v144, v144
    v_exp_f32 v145, v145
    v_mfma_f32_32x32x16_bf16 v[96:111], v[24:27], v[128:131], v[96:111]
    v_exp_f32 v146, v146
    v_exp_f32 v147, v147
    v_exp_f32 v148, v148
    v_exp_f32 v149, v149
    v_mfma_f32_32x32x16_bf16 v[96:111], v[28:31], v[132:135], v[96:111]
    v_exp_f32 v150, v150
    v_exp_f32 v151, v151
    v_exp_f32 v152, v152
    v_exp_f32 v153, v153
    v_exp_f32 v154, v154
    v_exp_f32 v155, v155
    v_exp_f32 v156, v156
    v_exp_f32 v157, v157
    v_exp_f32 v158, v158
    v_exp_f32 v159, v159
    v_cvt_pk_bf16_f32 v144, v144, v145
    v_cvt_pk_bf16_f32 v145, v146, v147
    v_cvt_pk_bf16_f32 v146, v148, v149
    v_cvt_pk_bf16_f32 v147, v150, v151
    v_cvt_pk_bf16_f32 v148, v152, v153
    v_cvt_pk_bf16_f32 v149, v154, v155
    v_cvt_pk_bf16_f32 v150, v156, v157
    v_cvt_pk_bf16_f32 v151, v158, v159
    v_pk_fma_f32 v[160:161], v[160:161], s[42:43], v[8:9] op_sel_hi:[1,1,0]
    v_pk_fma_f32 v[162:163], v[162:163], s[42:43], v[8:9] op_sel_hi:[1,1,0]
    v_pk_fma_f32 v[164:165], v[164:165], s[42:43], v[8:9] op_sel_hi:[1,1,0]
    v_pk_fma_f32 v[166:167], v[166:167], s[42:43], v[8:9] op_sel_hi:[1,1,0]
    v_pk_fma_f32 v[168:169], v[168:169], s[42:43], v[8:9] op_sel_hi:[1,1,0]
    v_pk_fma_f32 v[170:171], v[170:171], s[42:43], v[8:9] op_sel_hi:[1,1,0]
    v_pk_fma_f32 v[172:173], v[172:173], s[42:43], v[8:9] op_sel_hi:[1,1,0]
    v_pk_fma_f32 v[174:175], v[174:175], s[42:43], v[8:9] op_sel_hi:[1,1,0]
    v_exp_f32 v160, v160
    v_exp_f32 v161, v161
    v_mfma_f32_32x32x16_bf16 v[96:111], v[32:35], v[144:147], v[96:111]
    v_exp_f32 v162, v162
    v_exp_f32 v163, v163
    v_exp_f32 v164, v164
    v_exp_f32 v165, v165
    v_mfma_f32_32x32x16_bf16 v[96:111], v[36:39], v[148:151], v[96:111]
    v_exp_f32 v166, v166
    v_exp_f32 v167, v167
    v_exp_f32 v168, v168
    v_exp_f32 v169, v169
    v_exp_f32 v170, v170
    v_exp_f32 v171, v171
    v_exp_f32 v172, v172
    v_exp_f32 v173, v173
    v_exp_f32 v174, v174
    v_exp_f32 v175, v175
    v_cvt_pk_bf16_f32 v160, v160, v161
    v_cvt_pk_bf16_f32 v161, v162, v163
    v_cvt_pk_bf16_f32 v162, v164, v165
    v_cvt_pk_bf16_f32 v163, v166, v167
    v_cvt_pk_bf16_f32 v164, v168, v169
    v_cvt_pk_bf16_f32 v165, v170, v171
    v_cvt_pk_bf16_f32 v166, v172, v173
    v_cvt_pk_bf16_f32 v167, v174, v175
    v_pk_fma_f32 v[176:177], v[176:177], s[42:43], v[8:9] op_sel_hi:[1,1,0]
    v_pk_fma_f32 v[178:179], v[178:179], s[42:43], v[8:9] op_sel_hi:[1,1,0]
    v_pk_fma_f32 v[180:181], v[180:181], s[42:43], v[8:9] op_sel_hi:[1,1,0]
    v_pk_fma_f32 v[182:183], v[182:183], s[42:43], v[8:9] op_sel_hi:[1,1,0]
    v_pk_fma_f32 v[184:185], v[184:185], s[42:43], v[8:9] op_sel_hi:[1,1,0]
    v_pk_fma_f32 v[186:187], v[186:187], s[42:43], v[8:9] op_sel_hi:[1,1,0]
    v_pk_fma_f32 v[188:189], v[188:189], s[42:43], v[8:9] op_sel_hi:[1,1,0]
    v_pk_fma_f32 v[190:191], v[190:191], s[42:43], v[8:9] op_sel_hi:[1,1,0]
    v_exp_f32 v176, v176
    v_exp_f32 v177, v177
    v_mfma_f32_32x32x16_bf16 v[96:111], v[40:43], v[160:163], v[96:111]
    v_exp_f32 v178, v178
    v_exp_f32 v179, v179
    v_exp_f32 v180, v180
    v_exp_f32 v181, v181
    v_mfma_f32_32x32x16_bf16 v[96:111], v[44:47], v[164:167], v[96:111]
    v_exp_f32 v182, v182
    v_exp_f32 v183, v183
    v_exp_f32 v184, v184
    v_exp_f32 v185, v185
    v_exp_f32 v186, v186
    v_exp_f32 v187, v187
    v_exp_f32 v188, v188
    v_exp_f32 v189, v189
    v_exp_f32 v190, v190
    v_exp_f32 v191, v191
    v_cvt_pk_bf16_f32 v176, v176, v177
    v_cvt_pk_bf16_f32 v177, v178, v179
    v_cvt_pk_bf16_f32 v178, v180, v181
    v_cvt_pk_bf16_f32 v179, v182, v183
    v_cvt_pk_bf16_f32 v180, v184, v185
    v_cvt_pk_bf16_f32 v181, v186, v187
    v_cvt_pk_bf16_f32 v182, v188, v189
    v_cvt_pk_bf16_f32 v183, v190, v191
    v_pk_fma_f32 v[192:193], v[192:193], s[42:43], v[8:9] op_sel_hi:[1,1,0]
    v_pk_fma_f32 v[194:195], v[194:195], s[42:43], v[8:9] op_sel_hi:[1,1,0]
    v_pk_fma_f32 v[196:197], v[196:197], s[42:43], v[8:9] op_sel_hi:[1,1,0]
    v_pk_fma_f32 v[198:199], v[198:199], s[42:43], v[8:9] op_sel_hi:[1,1,0]
    v_pk_fma_f32 v[200:201], v[200:201], s[42:43], v[8:9] op_sel_hi:[1,1,0]
    v_pk_fma_f32 v[202:203], v[202:203], s[42:43], v[8:9] op_sel_hi:[1,1,0]
    v_pk_fma_f32 v[204:205], v[204:205], s[42:43], v[8:9] op_sel_hi:[1,1,0]
    v_pk_fma_f32 v[206:207], v[206:207], s[42:43], v[8:9] op_sel_hi:[1,1,0]
    v_exp_f32 v192, v192
    v_exp_f32 v193, v193
    v_mfma_f32_32x32x16_bf16 v[96:111], v[48:51], v[176:179], v[96:111]
    v_exp_f32 v194, v194
    v_exp_f32 v195, v195
    v_exp_f32 v196, v196
    v_exp_f32 v197, v197
    v_mfma_f32_32x32x16_bf16 v[96:111], v[52:55], v[180:183], v[96:111]
    v_exp_f32 v198, v198
    v_exp_f32 v199, v199
    v_exp_f32 v200, v200
    v_exp_f32 v201, v201
    v_exp_f32 v202, v202
    v_exp_f32 v203, v203
    v_exp_f32 v204, v204
    v_exp_f32 v205, v205
    v_exp_f32 v206, v206
    v_exp_f32 v207, v207
    v_cvt_pk_bf16_f32 v192, v192, v193
    v_cvt_pk_bf16_f32 v193, v194, v195
    v_cvt_pk_bf16_f32 v194, v196, v197
    v_cvt_pk_bf16_f32 v195, v198, v199
    v_cvt_pk_bf16_f32 v196, v200, v201
    v_cvt_pk_bf16_f32 v197, v202, v203
    v_cvt_pk_bf16_f32 v198, v204, v205
    v_cvt_pk_bf16_f32 v199, v206, v207
    v_pk_fma_f32 v[208:209], v[208:209], s[42:43], v[8:9] op_sel_hi:[1,1,0]
    v_pk_fma_f32 v[210:211], v[210:211], s[42:43], v[8:9] op_sel_hi:[1,1,0]
    v_pk_fma_f32 v[212:213], v[212:213], s[42:43], v[8:9] op_sel_hi:[1,1,0]
    v_pk_fma_f32 v[214:215], v[214:215], s[42:43], v[8:9] op_sel_hi:[1,1,0]
    v_pk_fma_f32 v[216:217], v[216:217], s[42:43], v[8:9] op_sel_hi:[1,1,0]
    v_pk_fma_f32 v[218:219], v[218:219], s[42:43], v[8:9] op_sel_hi:[1,1,0]
    v_pk_fma_f32 v[220:221], v[220:221], s[42:43], v[8:9] op_sel_hi:[1,1,0]
    v_pk_fma_f32 v[222:223], v[222:223], s[42:43], v[8:9] op_sel_hi:[1,1,0]
    v_exp_f32 v208, v208
    v_exp_f32 v209, v209
    v_mfma_f32_32x32x16_bf16 v[96:111], v[56:59], v[192:195], v[96:111]
    v_exp_f32 v210, v210
    v_exp_f32 v211, v211
    v_exp_f32 v212, v212
    v_exp_f32 v213, v213
    v_mfma_f32_32x32x16_bf16 v[96:111], v[60:63], v[196:199], v[96:111]
    v_exp_f32 v214, v214
    v_exp_f32 v215, v215
    v_exp_f32 v216, v216
    v_exp_f32 v217, v217
    v_exp_f32 v218, v218
    v_exp_f32 v219, v219
    v_exp_f32 v220, v220
    v_exp_f32 v221, v221
    v_exp_f32 v222, v222
    v_exp_f32 v223, v223
    v_cvt_pk_bf16_f32 v208, v208, v209
    v_cvt_pk_bf16_f32 v209, v210, v211
    v_cvt_pk_bf16_f32 v210, v212, v213
    v_cvt_pk_bf16_f32 v211, v214, v215
    v_cvt_pk_bf16_f32 v212, v216, v217
    v_cvt_pk_bf16_f32 v213, v218, v219
    v_cvt_pk_bf16_f32 v214, v220, v221
    v_cvt_pk_bf16_f32 v215, v222, v223
    v_pk_fma_f32 v[224:225], v[224:225], s[42:43], v[8:9] op_sel_hi:[1,1,0]
    v_pk_fma_f32 v[226:227], v[226:227], s[42:43], v[8:9] op_sel_hi:[1,1,0]
    v_pk_fma_f32 v[228:229], v[228:229], s[42:43], v[8:9] op_sel_hi:[1,1,0]
    v_pk_fma_f32 v[230:231], v[230:231], s[42:43], v[8:9] op_sel_hi:[1,1,0]
    v_pk_fma_f32 v[232:233], v[232:233], s[42:43], v[8:9] op_sel_hi:[1,1,0]
    v_pk_fma_f32 v[234:235], v[234:235], s[42:43], v[8:9] op_sel_hi:[1,1,0]
    v_pk_fma_f32 v[236:237], v[236:237], s[42:43], v[8:9] op_sel_hi:[1,1,0]
    v_pk_fma_f32 v[238:239], v[238:239], s[42:43], v[8:9] op_sel_hi:[1,1,0]
    v_exp_f32 v224, v224
    v_exp_f32 v225, v225
    v_mfma_f32_32x32x16_bf16 v[96:111], v[64:67], v[208:211], v[96:111]
    v_exp_f32 v226, v226
    v_exp_f32 v227, v227
    v_exp_f32 v228, v228
    v_exp_f32 v229, v229
    v_mfma_f32_32x32x16_bf16 v[96:111], v[68:71], v[212:215], v[96:111]
    v_exp_f32 v230, v230
    v_exp_f32 v231, v231
    v_exp_f32 v232, v232
    v_exp_f32 v233, v233
    v_exp_f32 v234, v234
    v_exp_f32 v235, v235
    v_exp_f32 v236, v236
    v_exp_f32 v237, v237
    v_exp_f32 v238, v238
    v_exp_f32 v239, v239
    v_cvt_pk_bf16_f32 v224, v224, v225
    v_cvt_pk_bf16_f32 v225, v226, v227
    v_cvt_pk_bf16_f32 v226, v228, v229
    v_cvt_pk_bf16_f32 v227, v230, v231
    v_cvt_pk_bf16_f32 v228, v232, v233
    v_cvt_pk_bf16_f32 v229, v234, v235
    v_cvt_pk_bf16_f32 v230, v236, v237
    v_cvt_pk_bf16_f32 v231, v238, v239
    v_mfma_f32_32x32x16_bf16 v[96:111], v[72:75], v[224:227], v[96:111]
    s_nop 0
    v_mfma_f32_32x32x16_bf16 v[96:111], v[76:79], v[228:231], v[96:111]
    v_lshlrev_b32 v8, 4, v2
    v_lshl_add_u32 v8, v3, 10, v8
    v_lshlrev_b32 v12, 3, v2
    s_waitcnt vmcnt(0)
    s_lshl_b32 s38, s34, 2
    v_mov_b32 v11, s38
    v_mov_b32 v94, 1
    ds_write_b32 v11, v94 offset:45440
    s_nop 3
    v_rcp_f32 v9, v108
    s_nop 0
    v_mul_f32 v9, v9, v4
    v_mul_f32 v96, v96, v9
    v_mul_f32 v97, v97, v9
    v_mul_f32 v98, v98, v9
    v_mul_f32 v99, v99, v9
    v_mul_f32 v100, v100, v9
    v_mul_f32 v101, v101, v9
    v_mul_f32 v102, v102, v9
    v_mul_f32 v103, v103, v9
    v_mul_f32 v104, v104, v9
    v_mul_f32 v105, v105, v9
    v_mul_f32 v106, v106, v9
    v_mul_f32 v107, v107, v9
    v_cvt_pk_bf16_f32 v88, v96, v97
    v_cvt_pk_bf16_f32 v89, v98, v99
    v_cvt_pk_bf16_f32 v90, v100, v101
    v_cvt_pk_bf16_f32 v91, v102, v103
    v_cvt_pk_bf16_f32 v92, v104, v105
    v_cvt_pk_bf16_f32 v93, v106, v107
    buffer_store_dwordx4 v[88:91], v8, s[12:15], s41 offen sc1
    s_mov_b32 exec_hi, 0
    buffer_store_dwordx2 v[92:93], v12, s[12:15], s40 offen sc1
    s_mov_b32 exec_hi, -1
    s_waitcnt vmcnt(0)
    v_mov_b32 v12, 1
    s_mov_b64 exec, 1
    buffer_store_dword v12, off, s[12:15], s85 sc1
    s_mov_b64 exec, -1
    s_endpgm
ATT_A:
    ds_read_b64 v[40:41], v7 offset:768
    ds_read_b64 v[42:43], v7 offset:4896
    ds_read_b64 v[44:45], v8 offset:768
    s_waitcnt lgkmcnt(12)
    v_mfma_f32_32x32x16_bf16 v[240:255], v[16:19], v[96:99], 0
    v_mfma_f32_32x32x8_bf16 v[240:255], v[20:21], v[100:101], v[240:255]
    ds_read_b64 v[46:47], v7 offset:1024
    ds_read_b64 v[48:49], v7 offset:5152
    ds_read_b64 v[50:51], v8 offset:1024
    s_waitcnt lgkmcnt(12)
    v_mfma_f32_32x32x16_bf16 v[112:127], v[22:25], v[96:99], 0
    v_mfma_f32_32x32x8_bf16 v[112:127], v[26:27], v[100:101], v[112:127]
    ds_read_b64 v[52:53], v7 offset:1280
    ds_read_b64 v[54:55], v7 offset:5408
    ds_read_b64 v[56:57], v8 offset:1280
    s_waitcnt lgkmcnt(12)
    v_mfma_f32_32x32x16_bf16 v[128:143], v[28:31], v[96:99], 0
    v_mfma_f32_32x32x8_bf16 v[128:143], v[32:33], v[100:101], v[128:143]
    ds_read_b64 v[58:59], v7 offset:1536
    ds_read_b64 v[60:61], v7 offset:5664
    ds_read_b64 v[62:63], v8 offset:1536
    s_waitcnt lgkmcnt(12)
    v_mfma_f32_32x32x16_bf16 v[144:159], v[34:37], v[96:99], 0
    s_cmp_lt_u32 s78, 8
    s_cbranch_scc1 FIXA0
NOFIXA0:
    v_cndmask_b32 v240, v112, v240, s[44:45]
    v_cndmask_b32 v241, v113, v241, s[46:47]
    v_cndmask_b32 v242, v114, v242, s[48:49]
    v_cndmask_b32 v243, v115, v243, s[50:51]
    v_cndmask_b32 v244, v116, v244, s[52:53]
    v_cndmask_b32 v245, v117, v245, s[54:55]
    v_cndmask_b32 v246, v118, v246, s[56:57]
    v_mfma_f32_32x32x8_bf16 v[144:159], v[38:39], v[100:101], v[144:159]
    v_cndmask_b32 v247, v119, v247, s[58:59]
    v_cndmask_b32 v248, v120, v248, s[60:61]
    v_cndmask_b32 v249, v121, v249, s[62:63]
    v_cndmask_b32 v250, v122, v250, s[64:65]
    v_cndmask_b32 v251, v123, v251, s[66:67]
    v_cndmask_b32 v252, v124, v252, s[68:69]
    v_cndmask_b32 v253, v125, v253, s[70:71]
    v_cndmask_b32 v254, v126, v254, s[72:73]
    v_cndmask_b32 v255, v127, v255, s[74:75]
    ds_read_b64 v[64:65], v7 offset:1792
    ds_read_b64 v[66:67], v7 offset:5920
    ds_read_b64 v[68:69], v8 offset:1792
    s_waitcnt lgkmcnt(12)
    v_mfma_f32_32x32x16_bf16 v[160:175], v[40:43], v[96:99], 0
    v_max_f32 v112, v240, v241
    v_max_f32 v113, v242, v243
    v_max_f32 v114, v244, v245
    v_max_f32 v115, v246, v247
    v_max3_f32 v112, v248, v249, v112
    v_max3_f32 v113, v250, v251, v113
    v_max3_f32 v114, v252, v253, v114
    v_max3_f32 v115, v254, v255, v115
    v_mfma_f32_32x32x8_bf16 v[160:175], v[44:45], v[100:101], v[160:175]
    s_cmp_lt_u32 s78, 7
    s_cbranch_scc1 FIXA1
NOFIXA1:
    v_max3_f32 v112, v128, v129, v112
    v_max3_f32 v113, v130, v131, v113
    v_max3_f32 v114, v132, v133, v114
    v_max3_f32 v115, v134, v135, v115
    v_max3_f32 v112, v136, v137, v112
    v_max3_f32 v113, v138, v139, v113
    v_max3_f32 v114, v140, v141, v114
    v_max3_f32 v115, v142, v143, v115
    s_waitcnt lgkmcnt(9)
    v_mfma_f32_32x32x16_bf16 v[176:191], v[46:49], v[96:99], 0
    s_cmp_lt_u32 s78, 6
    s_cbranch_scc1 FIXA2
NOFIXA2:
    v_max3_f32 v112, v144, v145, v112
    v_max3_f32 v113, v146, v147, v113
    v_max3_f32 v114, v148, v149, v114
    v_mfma_f32_32x32x8_bf16 v[176:191], v[50:51], v[100:101], v[176:191]
    v_max3_f32 v115, v150, v151, v115
    v_max3_f32 v112, v152, v153, v112
    v_max3_f32 v113, v154, v155, v113
    v_max3_f32 v114, v156, v157, v114
    v_max3_f32 v115, v158, v159, v115
    s_waitcnt lgkmcnt(6)
    v_mfma_f32_32x32x16_bf16 v[192:207], v[52:55], v[96:99], 0
    s_cmp_lt_u32 s78, 5
    s_cbranch_scc1 FIXA3
NOFIXA3:
    v_max3_f32 v112, v160, v161, v112
    v_max3_f32 v113, v162, v163, v113
    v_max3_f32 v114, v164, v165, v114
    v_mfma_f32_32x32x8_bf16 v[192:207], v[56:57], v[100:101], v[192:207]
    v_max3_f32 v115, v166, v167, v115
    v_max3_f32 v112, v168, v169, v112
    v_max3_f32 v113, v170, v171, v113
    v_max3_f32 v114, v172, v173, v114
    v_max3_f32 v115, v174, v175, v115
    s_waitcnt lgkmcnt(3)
    v_mfma_f32_32x32x16_bf16 v[208:223], v[58:61], v[96:99], 0
    s_cmp_lt_u32 s78, 4
    s_cbranch_scc1 FIXA4
NOFIXA4:
    v_max3_f32 v112, v176, v177, v112
    v_max3_f32 v113, v178, v179, v113
    v_max3_f32 v114, v180, v181, v114
    v_mfma_f32_32x32x8_bf16 v[208:223], v[62:63], v[100:101], v[208:223]
    v_max3_f32 v115, v182, v183, v115
    v_max3_f32 v112, v184, v185, v112
    v_max3_f32 v113, v186, v187, v113
    v_max3_f32 v114, v188, v189, v114
    v_max3_f32 v115, v190, v191, v115
    s_waitcnt lgkmcnt(0)
    v_mfma_f32_32x32x16_bf16 v[224:239], v[64:67], v[96:99], 0
    s_cmp_lt_u32 s78, 3
    s_cbranch_scc1 FIXA5
NOFIXA5:
    v_max3_f32 v112, v192, v193, v112
    v_max3_f32 v113, v194, v195, v113
    v_max3_f32 v114, v196, v197, v114
    v_mfma_f32_32x32x8_bf16 v[224:239], v[68:69], v[100:101], v[224:239]
    v_max3_f32 v115, v198, v199, v115
    v_max3_f32 v112, v200, v201, v112
    v_max3_f32 v113, v202, v203, v113
    v_max3_f32 v114, v204, v205, v114
    v_max3_f32 v115, v206, v207, v115
    ds_read_b64_tr_b16 v[80:81], v10 offset:2048
    ds_read_b64_tr_b16 v[82:83], v10 offset:2080
    ds_read_b64_tr_b16 v[84:85], v10 offset:2176
    ds_read_b64_tr_b16 v[86:87], v10 offset:2208
    ds_read_b64_tr_b16 v[16:17], v10 offset:0
    ds_read_b64_tr_b16 v[18:19], v10 offset:32
    ds_read_b64_tr_b16 v[20:21], v10 offset:128
    ds_read_b64_tr_b16 v[22:23], v10 offset:160
    ds_read_b64_tr_b16 v[24:25], v10 offset:256
    ds_read_b64_tr_b16 v[26:27], v10 offset:288
    ds_read_b64_tr_b16 v[28:29], v10 offset:384
    ds_read_b64_tr_b16 v[30:31], v10 offset:416
    s_cmp_lt_u32 s78, 2
    s_cbranch_scc1 FIXA6
NOFIXA6:
    v_max3_f32 v112, v208, v209, v112
    v_max3_f32 v113, v210, v211, v113
    v_max3_f32 v114, v212, v213, v114
    v_max3_f32 v115, v214, v215, v115
    v_max3_f32 v112, v216, v217, v112
    v_max3_f32 v113, v218, v219, v113
    s_branch PN4
.p2align 12
PG4:
    s_branch WARMED
PN4:
    v_max3_f32 v114, v220, v221, v114
    v_max3_f32 v115, v222, v223, v115
    s_cmp_lt_u32 s78, 1
    s_cbranch_scc1 FIXA7
NOFIXA7:
    v_max3_f32 v112, v224, v225, v112
    v_max3_f32 v113, v226, v227, v113
    v_max3_f32 v114, v228, v229, v114
    v_max3_f32 v115, v230, v231, v115
    v_max3_f32 v112, v232, v233, v112
    v_max3_f32 v113, v234, v235, v113
    v_max3_f32 v114, v236, v237, v114
    v_max3_f32 v115, v238, v239, v115
    v_max3_f32 v112, v112, v113, v114
    v_max_f32 v112, v112, v115
    v_mov_b32 v113, v112
    s_mov_b32 s42, 0x3ea52b5c
    s_mov_b32 s43, 0x3ea52b5c
    v_permlane32_swap_b32 v112, v113
    v_max_f32 v112, v112, v113
    v_mul_f32 v8, 0xbea52b5c, v112
    v_pk_fma_f32 v[240:241], v[240:241], s[42:43], v[8:9] op_sel_hi:[1,1,0]
    ds_read_b64_tr_b16 v[32:33], v10 offset:512
    v_pk_fma_f32 v[242:243], v[242:243], s[42:43], v[8:9] op_sel_hi:[1,1,0]
    s_mul_i32 s35, s26, 278528
    s_lshl_b32 s38, s30, 12
    s_add_u32 s35, s35, s38
    s_add_u32 s35, s35, 8388608
    s_lshl_b32 s48, s28, 1
    s_and_b32 s48, s48, 0
    v_lshlrev_b32 v12, 4, v13
    v_lshl_add_u32 v12, v14, 10, v12
    v_pk_fma_f32 v[244:245], v[244:245], s[42:43], v[8:9] op_sel_hi:[1,1,0]
    ds_read_b64_tr_b16 v[34:35], v10 offset:544
    v_pk_fma_f32 v[246:247], v[246:247], s[42:43], v[8:9] op_sel_hi:[1,1,0]
    v_pk_fma_f32 v[248:249], v[248:249], s[42:43], v[8:9] op_sel_hi:[1,1,0]
    ds_read_b64_tr_b16 v[36:37], v10 offset:640
    s_add_u32 s44, s30, 0
    s_and_b32 s44, s44, 3
    s_lshl_b32 s38, s44, 8
    v_add_u32 v5, s38, v12
    v_pk_fma_f32 v[250:251], v[250:251], s[42:43], v[8:9] op_sel_hi:[1,1,0]
    v_pk_fma_f32 v[252:253], v[252:253], s[42:43], v[8:9] op_sel_hi:[1,1,0]
    ds_read_b64_tr_b16 v[38:39], v10 offset:672
    v_pk_fma_f32 v[254:255], v[254:255], s[42:43], v[8:9] op_sel_hi:[1,1,0]
    v_exp_f32 v240, v240
    s_add_u32 s45, s30, 1
    s_and_b32 s45, s45, 3
    s_lshl_b32 s38, s45, 8
    v_add_u32 v6, s38, v12
    ds_read_b64_tr_b16 v[40:41], v10 offset:768
    v_exp_f32 v241, v241
    v_exp_f32 v242, v242
    ds_read_b64_tr_b16 v[42:43], v10 offset:800
    v_exp_f32 v243, v243
    s_add_u32 s46, s30, 2
    s_and_b32 s46, s46, 3
    s_lshl_b32 s38, s46, 8
    v_add_u32 v7, s38, v12
    v_exp_f32 v244, v244
    ds_read_b64_tr_b16 v[44:45], v10 offset:896
    v_exp_f32 v245, v245
    v_exp_f32 v246, v246
    ds_read_b64_tr_b16 v[46:47], v10 offset:928
    s_add_u32 s47, s30, 3
    s_and_b32 s47, s47, 3
    s_lshl_b32 s38, s47, 8
    v_add_u32 v11, s38, v12
    v_exp_f32 v247, v247
    v_exp_f32 v248, v248
    ds_read_b64_tr_b16 v[48:49], v10 offset:1024
    v_exp_f32 v249, v249
    v_exp_f32 v250, v250
    ds_read_b64_tr_b16 v[50:51], v10 offset:1056
    v_exp_f32 v251, v251
    v_exp_f32 v252, v252
    ds_read_b64_tr_b16 v[52:53], v10 offset:1152
    v_exp_f32 v253, v253
    v_exp_f32 v254, v254
    ds_read_b64_tr_b16 v[54:55], v10 offset:1184
    v_exp_f32 v255, v255
    v_cvt_pk_bf16_f32 v240, v240, v241
    v_cvt_pk_bf16_f32 v241, v242, v243
    v_cvt_pk_bf16_f32 v242, v244, v245
    v_cvt_pk_bf16_f32 v243, v246, v247
    v_cvt_pk_bf16_f32 v244, v248, v249
    v_cvt_pk_bf16_f32 v245, v250, v251
    v_cvt_pk_bf16_f32 v246, v252, v253
    v_cvt_pk_bf16_f32 v247, v254, v255
    v_bfi_b32 v112, v104, 0, v240
    v_and_b32 v240, v104, v240
    v_bfi_b32 v113, v105, 0, v241
    v_and_b32 v241, v105, v241
    v_bfi_b32 v114, v106, 0, v242
    v_and_b32 v242, v106, v242
    v_bfi_b32 v115, v107, 0, v243
    v_and_b32 v243, v107, v243
    v_bfi_b32 v116, v108, 0, v244
    v_and_b32 v244, v108, v244
    v_bfi_b32 v117, v109, 0, v245
    v_and_b32 v245, v109, v245
    v_bfi_b32 v118, v110, 0, v246
    v_and_b32 v246, v110, v246
    v_bfi_b32 v119, v111, 0, v247
    v_and_b32 v247, v111, v247
    s_waitcnt lgkmcnt(0)
    v_pk_fma_f32 v[128:129], v[128:129], s[42:43], v[8:9] op_sel_hi:[1,1,0]
    ds_read_b64_tr_b16 v[56:57], v10 offset:1280
    v_pk_fma_f32 v[130:131], v[130:131], s[42:43], v[8:9] op_sel_hi:[1,1,0]
    v_pk_fma_f32 v[132:133], v[132:133], s[42:43], v[8:9] op_sel_hi:[1,1,0]
    ds_read_b64_tr_b16 v[58:59], v10 offset:1312
    v_pk_fma_f32 v[134:135], v[134:135], s[42:43], v[8:9] op_sel_hi:[1,1,0]
    v_pk_fma_f32 v[136:137], v[136:137], s[42:43], v[8:9] op_sel_hi:[1,1,0]
    ds_read_b64_tr_b16 v[60:61], v10 offset:1408
    v_pk_fma_f32 v[138:139], v[138:139], s[42:43], v[8:9] op_sel_hi:[1,1,0]
    v_pk_fma_f32 v[140:141], v[140:141], s[42:43], v[8:9] op_sel_hi:[1,1,0]
    ds_read_b64_tr_b16 v[62:63], v10 offset:1440
    v_pk_fma_f32 v[142:143], v[142:143], s[42:43], v[8:9] op_sel_hi:[1,1,0]
    v_exp_f32 v128, v128
    ds_read_b64_tr_b16 v[64:65], v10 offset:1536
    v_exp_f32 v129, v129
    v_mfma_f32_32x32x16_bf16 v[96:111], v[80:83], v[240:243], 0
    ds_read_b64_tr_b16 v[66:67], v10 offset:1568
    v_exp_f32 v130, v130
    v_exp_f32 v131, v131
    ds_read_b64_tr_b16 v[68:69], v10 offset:1664
    v_exp_f32 v132, v132
    v_exp_f32 v133, v133
    ds_read_b64_tr_b16 v[70:71], v10 offset:1696
    v_mfma_f32_32x32x16_bf16 v[96:111], v[84:87], v[244:247], v[96:111]
    v_exp_f32 v134, v134
    ds_read_b64_tr_b16 v[72:73], v10 offset:1792
    v_exp_f32 v135, v135
    v_exp_f32 v136, v136
    ds_read_b64_tr_b16 v[74:75], v10 offset:1824
    v_exp_f32 v137, v137
    v_mfma_f32_32x32x16_bf16 v[96:111], v[16:19], v[112:115], v[96:111]
    ds_read_b64_tr_b16 v[76:77], v10 offset:1920
    v_exp_f32 v138, v138
    v_exp_f32 v139, v139
    ds_read_b64_tr_b16 v[78:79], v10 offset:1952
    v_exp_f32 v140, v140
    v_exp_f32 v141, v141
    v_mfma_f32_32x32x16_bf16 v[96:111], v[20:23], v[116:119], v[96:111]
    v_exp_f32 v142, v142
    v_exp_f32 v143, v143
    v_cvt_pk_bf16_f32 v128, v128, v129
    v_cvt_pk_bf16_f32 v129, v130, v131
    v_cvt_pk_bf16_f32 v130, v132, v133
    v_cvt_pk_bf16_f32 v131, v134, v135
    v_cvt_pk_bf16_f32 v132, v136, v137
    v_cvt_pk_bf16_f32 v133, v138, v139
    v_cvt_pk_bf16_f32 v134, v140, v141
    v_cvt_pk_bf16_f32 v135, v142, v143
    s_waitcnt lgkmcnt(0)
    v_pk_fma_f32 v[144:145], v[144:145], s[42:43], v[8:9] op_sel_hi:[1,1,0]
    v_pk_fma_f32 v[146:147], v[146:147], s[42:43], v[8:9] op_sel_hi:[1,1,0]
    v_pk_fma_f32 v[148:149], v[148:149], s[42:43], v[8:9] op_sel_hi:[1,1,0]
    s_lshl_b32 s83, s26, 9
    s_add_u32 s83, s83, 22102016
    v_lshlrev_b32 v95, 3, v0
    buffer_load_dword v94, v95, s[12:15], s83 offen sc1
    v_lshlrev_b32 v92, 4, v0
    buffer_load_dwordx4 v[88:91], v92, s[12:15], s79 offen sc1
    v_pk_fma_f32 v[150:151], v[150:151], s[42:43], v[8:9] op_sel_hi:[1,1,0]
    v_pk_fma_f32 v[152:153], v[152:153], s[42:43], v[8:9] op_sel_hi:[1,1,0]
    v_pk_fma_f32 v[154:155], v[154:155], s[42:43], v[8:9] op_sel_hi:[1,1,0]
    v_pk_fma_f32 v[156:157], v[156:157], s[42:43], v[8:9] op_sel_hi:[1,1,0]
    v_pk_fma_f32 v[158:159], v[158:159], s[42:43], v[8:9] op_sel_hi:[1,1,0]
    v_exp_f32 v144, v144
    v_exp_f32 v145, v145
    v_mfma_f32_32x32x16_bf16 v[96:111], v[24:27], v[128:131], v[96:111]
    v_exp_f32 v146, v146
    v_exp_f32 v147, v147
    v_exp_f32 v148, v148
    v_exp_f32 v149, v149
    v_mfma_f32_32x32x16_bf16 v[96:111], v[28:31], v[132:135], v[96:111]
    v_exp_f32 v150, v150
    v_exp_f32 v151, v151
    v_exp_f32 v152, v152
    v_exp_f32 v153, v153
    v_exp_f32 v154, v154
    v_exp_f32 v155, v155
    v_exp_f32 v156, v156
    v_exp_f32 v157, v157
    v_exp_f32 v158, v158
    v_exp_f32 v159, v159
    v_cvt_pk_bf16_f32 v144, v144, v145
    v_cvt_pk_bf16_f32 v145, v146, v147
    v_cvt_pk_bf16_f32 v146, v148, v149
    v_cvt_pk_bf16_f32 v147, v150, v151
    v_cvt_pk_bf16_f32 v148, v152, v153
    v_cvt_pk_bf16_f32 v149, v154, v155
    v_cvt_pk_bf16_f32 v150, v156, v157
    v_cvt_pk_bf16_f32 v151, v158, v159
    v_pk_fma_f32 v[160:161], v[160:161], s[42:43], v[8:9] op_sel_hi:[1,1,0]
    v_pk_fma_f32 v[162:163], v[162:163], s[42:43], v[8:9] op_sel_hi:[1,1,0]
    v_pk_fma_f32 v[164:165], v[164:165], s[42:43], v[8:9] op_sel_hi:[1,1,0]
    v_pk_fma_f32 v[166:167], v[166:167], s[42:43], v[8:9] op_sel_hi:[1,1,0]
    v_pk_fma_f32 v[168:169], v[168:169], s[42:43], v[8:9] op_sel_hi:[1,1,0]
    v_pk_fma_f32 v[170:171], v[170:171], s[42:43], v[8:9] op_sel_hi:[1,1,0]
    v_pk_fma_f32 v[172:173], v[172:173], s[42:43], v[8:9] op_sel_hi:[1,1,0]
    v_pk_fma_f32 v[174:175], v[174:175], s[42:43], v[8:9] op_sel_hi:[1,1,0]
    v_exp_f32 v160, v160
    v_exp_f32 v161, v161
    v_mfma_f32_32x32x16_bf16 v[96:111], v[32:35], v[144:147], v[96:111]
    v_exp_f32 v162, v162
    v_exp_f32 v163, v163
    v_exp_f32 v164, v164
    v_exp_f32 v165, v165
    v_mfma_f32_32x32x16_bf16 v[96:111], v[36:39], v[148:151], v[96:111]
    v_exp_f32 v166, v166
    v_exp_f32 v167, v167
    v_exp_f32 v168, v168
    v_exp_f32 v169, v169
    v_exp_f32 v170, v170
    v_exp_f32 v171, v171
    v_exp_f32 v172, v172
    v_exp_f32 v173, v173
    v_exp_f32 v174, v174
    v_exp_f32 v175, v175
    v_cvt_pk_bf16_f32 v160, v160, v161
    v_cvt_pk_bf16_f32 v161, v162, v163
    v_cvt_pk_bf16_f32 v162, v164, v165
    v_cvt_pk_bf16_f32 v163, v166, v167
    v_cvt_pk_bf16_f32 v164, v168, v169
    v_cvt_pk_bf16_f32 v165, v170, v171
    v_cvt_pk_bf16_f32 v166, v172, v173
    v_cvt_pk_bf16_f32 v167, v174, v175
    v_pk_fma_f32 v[176:177], v[176:177], s[42:43], v[8:9] op_sel_hi:[1,1,0]
    v_pk_fma_f32 v[178:179], v[178:179], s[42:43], v[8:9] op_sel_hi:[1,1,0]
    v_pk_fma_f32 v[180:181], v[180:181], s[42:43], v[8:9] op_sel_hi:[1,1,0]
    s_waitcnt vmcnt(0)
    s_mov_b32 s88, 0
SPIN3:
    v_and_b32 v88, v88, v89
    v_and_b32 v88, v88, v90
    v_and_b32 v88, v88, v91
    v_cmp_gt_u32 vcc, 1, v88
    s_add_u32 s88, s88, 1
    s_nop 0
    s_and_b64 vcc, vcc, -1
    s_cbranch_scc0 GO3
    s_cmp_gt_u32 s88, 0x20000
    s_cbranch_scc1 GO3
    s_sleep 8
    v_lshlrev_b32 v92, 4, v0
    buffer_load_dwordx4 v[88:91], v92, s[12:15], s79 offen sc1
    s_waitcnt vmcnt(0)
    s_branch SPIN3
GO3:
    s_lshl_b32 s38, s81, 10
    s_lshl_b32 s39, s30, 7
    s_add_u32 s38, s38, s39
    s_add_u32 s38, s38, 22020096
    v_lshlrev_b32 v88, 2, v2
    buffer_load_dword v4, v88, s[12:15], s38 offen sc1
    v_mov_b32 v12, 1
    s_mov_b64 exec, 1
    buffer_store_dword v12, off, s[12:15], s3 sc1
    s_mov_b64 exec, -1
    s_mov_b32 s88, 0
SPIN4:
    v_cmp_gt_u32 vcc, 1, v94
    s_add_u32 s88, s88, 1
    s_nop 0
    s_and_b64 vcc, vcc, -1
    s_cbranch_scc0 GO4
    s_cmp_gt_u32 s88, 0x20000
    s_cbranch_scc1 GO4
    s_sleep 8
    buffer_load_dword v94, v95, s[12:15], s83 offen sc1
    s_waitcnt vmcnt(0)
    s_branch SPIN4
GO4:
    v_pk_fma_f32 v[182:183], v[182:183], s[42:43], v[8:9] op_sel_hi:[1,1,0]
    v_pk_fma_f32 v[184:185], v[184:185], s[42:43], v[8:9] op_sel_hi:[1,1,0]
    v_pk_fma_f32 v[186:187], v[186:187], s[42:43], v[8:9] op_sel_hi:[1,1,0]
    v_pk_fma_f32 v[188:189], v[188:189], s[42:43], v[8:9] op_sel_hi:[1,1,0]
    v_pk_fma_f32 v[190:191], v[190:191], s[42:43], v[8:9] op_sel_hi:[1,1,0]
    s_add_u32 s38, s48, 0
    s_and_b32 s38, s38, 7
    s_mul_i32 s38, s38, 16384
    s_add_u32 s49, s35, s38
    v_exp_f32 v176, v176
    v_exp_f32 v177, v177
    v_mfma_f32_32x32x16_bf16 v[96:111], v[40:43], v[160:163], v[96:111]
    v_exp_f32 v178, v178
    v_exp_f32 v179, v179
    buffer_load_dwordx4 v[112:115], v5, s[12:15], s49 offen sc1
    v_exp_f32 v180, v180
    v_exp_f32 v181, v181
    v_mfma_f32_32x32x16_bf16 v[96:111], v[44:47], v[164:167], v[96:111]
    v_exp_f32 v182, v182
    v_exp_f32 v183, v183
    buffer_load_dwordx4 v[116:119], v6, s[12:15], s49 offen sc1
    v_exp_f32 v184, v184
    v_exp_f32 v185, v185
    v_exp_f32 v186, v186
    v_exp_f32 v187, v187
    v_exp_f32 v188, v188
    buffer_load_dwordx4 v[120:123], v7, s[12:15], s49 offen sc1
    v_exp_f32 v189, v189
    v_exp_f32 v190, v190
    v_exp_f32 v191, v191
    v_cvt_pk_bf16_f32 v176, v176, v177
    v_cvt_pk_bf16_f32 v177, v178, v179
    buffer_load_dwordx4 v[124:127], v11, s[12:15], s49 offen sc1
    v_cvt_pk_bf16_f32 v178, v180, v181
    v_cvt_pk_bf16_f32 v179, v182, v183
    v_cvt_pk_bf16_f32 v180, v184, v185
    v_cvt_pk_bf16_f32 v181, v186, v187
    v_cvt_pk_bf16_f32 v182, v188, v189
    v_cvt_pk_bf16_f32 v183, v190, v191
    v_pk_fma_f32 v[192:193], v[192:193], s[42:43], v[8:9] op_sel_hi:[1,1,0]
    v_pk_fma_f32 v[194:195], v[194:195], s[42:43], v[8:9] op_sel_hi:[1,1,0]
    v_pk_fma_f32 v[196:197], v[196:197], s[42:43], v[8:9] op_sel_hi:[1,1,0]
    s_add_u32 s38, s48, 1
    s_and_b32 s38, s38, 7
    s_mul_i32 s38, s38, 16384
    s_add_u32 s49, s35, s38
    v_pk_fma_f32 v[198:199], v[198:199], s[42:43], v[8:9] op_sel_hi:[1,1,0]
    v_pk_fma_f32 v[200:201], v[200:201], s[42:43], v[8:9] op_sel_hi:[1,1,0]
    v_pk_fma_f32 v[202:203], v[202:203], s[42:43], v[8:9] op_sel_hi:[1,1,0]
    v_pk_fma_f32 v[204:205], v[204:205], s[42:43], v[8:9] op_sel_hi:[1,1,0]
    v_pk_fma_f32 v[206:207], v[206:207], s[42:43], v[8:9] op_sel_hi:[1,1,0]
    buffer_load_dwordx4 v[128:131], v5, s[12:15], s49 offen sc1
    v_exp_f32 v192, v192
    v_exp_f32 v193, v193
    v_mfma_f32_32x32x16_bf16 v[96:111], v[48:51], v[176:179], v[96:111]
    v_exp_f32 v194, v194
    v_exp_f32 v195, v195
    buffer_load_dwordx4 v[132:135], v6, s[12:15], s49 offen sc1
    v_exp_f32 v196, v196
    v_exp_f32 v197, v197
    v_mfma_f32_32x32x16_bf16 v[96:111], v[52:55], v[180:183], v[96:111]
    v_exp_f32 v198, v198
    v_exp_f32 v199, v199
    buffer_load_dwordx4 v[136:139], v7, s[12:15], s49 offen sc1
    v_exp_f32 v200, v200
    v_exp_f32 v201, v201
    v_exp_f32 v202, v202
    v_exp_f32 v203, v203
    v_exp_f32 v204, v204
    buffer_load_dwordx4 v[140:143], v11, s[12:15], s49 offen sc1
    v_exp_f32 v205, v205
    v_exp_f32 v206, v206
    v_exp_f32 v207, v207
    v_cvt_pk_bf16_f32 v192, v192, v193
    v_cvt_pk_bf16_f32 v193, v194, v195
    v_cvt_pk_bf16_f32 v194, v196, v197
    v_cvt_pk_bf16_f32 v195, v198, v199
    v_cvt_pk_bf16_f32 v196, v200, v201
    v_cvt_pk_bf16_f32 v197, v202, v203
    v_cvt_pk_bf16_f32 v198, v204, v205
    v_cvt_pk_bf16_f32 v199, v206, v207
    v_pk_fma_f32 v[208:209], v[208:209], s[42:43], v[8:9] op_sel_hi:[1,1,0]
    v_pk_fma_f32 v[210:211], v[210:211], s[42:43], v[8:9] op_sel_hi:[1,1,0]
    v_pk_fma_f32 v[212:213], v[212:213], s[42:43], v[8:9] op_sel_hi:[1,1,0]
    s_add_u32 s38, s48, 2
    s_and_b32 s38, s38, 7
    s_mul_i32 s38, s38, 16384
    s_add_u32 s49, s35, s38
    v_pk_fma_f32 v[214:215], v[214:215], s[42:43], v[8:9] op_sel_hi:[1,1,0]
    v_pk_fma_f32 v[216:217], v[216:217], s[42:43], v[8:9] op_sel_hi:[1,1,0]
    v_pk_fma_f32 v[218:219], v[218:219], s[42:43], v[8:9] op_sel_hi:[1,1,0]
    v_pk_fma_f32 v[220:221], v[220:221], s[42:43], v[8:9] op_sel_hi:[1,1,0]
    v_pk_fma_f32 v[222:223], v[222:223], s[42:43], v[8:9] op_sel_hi:[1,1,0]
    buffer_load_dwordx4 v[144:147], v5, s[12:15], s49 offen sc1
    v_exp_f32 v208, v208
    v_exp_f32 v209, v209
    v_mfma_f32_32x32x16_bf16 v[96:111], v[56:59], v[192:195], v[96:111]
    v_exp_f32 v210, v210
    v_exp_f32 v211, v211
    buffer_load_dwordx4 v[148:151], v6, s[12:15], s49 offen sc1
    v_exp_f32 v212, v212
    v_exp_f32 v213, v213
    v_mfma_f32_32x32x16_bf16 v[96:111], v[60:63], v[196:199], v[96:111]
    v_exp_f32 v214, v214
    v_exp_f32 v215, v215
    buffer_load_dwordx4 v[152:155], v7, s[12:15], s49 offen sc1
    v_exp_f32 v216, v216
    v_exp_f32 v217, v217
    v_exp_f32 v218, v218
    v_exp_f32 v219, v219
    v_exp_f32 v220, v220
    buffer_load_dwordx4 v[156:159], v11, s[12:15], s49 offen sc1
    v_exp_f32 v221, v221
    v_exp_f32 v222, v222
    v_exp_f32 v223, v223
    v_cvt_pk_bf16_f32 v208, v208, v209
    v_cvt_pk_bf16_f32 v209, v210, v211
    v_cvt_pk_bf16_f32 v210, v212, v213
    v_cvt_pk_bf16_f32 v211, v214, v215
    v_cvt_pk_bf16_f32 v212, v216, v217
    v_cvt_pk_bf16_f32 v213, v218, v219
    v_cvt_pk_bf16_f32 v214, v220, v221
    v_cvt_pk_bf16_f32 v215, v222, v223
    v_pk_fma_f32 v[224:225], v[224:225], s[42:43], v[8:9] op_sel_hi:[1,1,0]
    v_pk_fma_f32 v[226:227], v[226:227], s[42:43], v[8:9] op_sel_hi:[1,1,0]
    v_pk_fma_f32 v[228:229], v[228:229], s[42:43], v[8:9] op_sel_hi:[1,1,0]
    v_pk_fma_f32 v[230:231], v[230:231], s[42:43], v[8:9] op_sel_hi:[1,1,0]
    v_pk_fma_f32 v[232:233], v[232:233], s[42:43], v[8:9] op_sel_hi:[1,1,0]
    v_pk_fma_f32 v[234:235], v[234:235], s[42:43], v[8:9] op_sel_hi:[1,1,0]
    v_pk_fma_f32 v[236:237], v[236:237], s[42:43], v[8:9] op_sel_hi:[1,1,0]
    v_pk_fma_f32 v[238:239], v[238:239], s[42:43], v[8:9] op_sel_hi:[1,1,0]
    v_exp_f32 v224, v224
    v_exp_f32 v225, v225
    v_mfma_f32_32x32x16_bf16 v[96:111], v[64:67], v[208:211], v[96:111]
    v_exp_f32 v226, v226
    v_exp_f32 v227, v227
    v_exp_f32 v228, v228
    v_exp_f32 v229, v229
    v_mfma_f32_32x32x16_bf16 v[96:111], v[68:71], v[212:215], v[96:111]
    v_exp_f32 v230, v230
    v_exp_f32 v231, v231
    v_exp_f32 v232, v232
    v_exp_f32 v233, v233
    v_exp_f32 v234, v234
    v_exp_f32 v235, v235
    v_exp_f32 v236, v236
    v_exp_f32 v237, v237
    v_exp_f32 v238, v238
    v_exp_f32 v239, v239
    v_cvt_pk_bf16_f32 v224, v224, v225
    v_cvt_pk_bf16_f32 v225, v226, v227
    v_cvt_pk_bf16_f32 v226, v228, v229
    v_cvt_pk_bf16_f32 v227, v230, v231
    v_cvt_pk_bf16_f32 v228, v232, v233
    v_cvt_pk_bf16_f32 v229, v234, v235
    v_cvt_pk_bf16_f32 v230, v236, v237
    v_cvt_pk_bf16_f32 v231, v238, v239
    v_mfma_f32_32x32x16_bf16 v[96:111], v[72:75], v[224:227], v[96:111]
    s_nop 0
    v_mfma_f32_32x32x16_bf16 v[96:111], v[76:79], v[228:231], v[96:111]
    v_lshlrev_b32 v8, 4, v2
    v_lshl_add_u32 v8, v3, 10, v8
    v_lshlrev_b32 v12, 3, v2
    v_add_u32 v2, 4096, v1
    s_add_u32 s38, s48, 0
    s_and_b32 s38, s38, 7
    s_mul_i32 s38, s38, 20480
    s_add_u32 s50, s36, s38
    buffer_load_dwordx4 v[176:179], v1, s[12:15], s50 offen offset:0 sc1
    buffer_load_dwordx4 v[180:183], v1, s[12:15], s50 offen offset:1024 sc1
    buffer_load_dwordx4 v[184:187], v1, s[12:15], s50 offen offset:2048 sc1
    buffer_load_dwordx4 v[188:191], v1, s[12:15], s50 offen offset:3072 sc1
    buffer_load_dwordx4 v[192:195], v2, s[12:15], s50 offen offset:0 sc1
    s_add_u32 s38, s48, 1
    s_and_b32 s38, s38, 7
    s_mul_i32 s38, s38, 20480
    s_add_u32 s50, s36, s38
    buffer_load_dwordx4 v[196:199], v1, s[12:15], s50 offen offset:0 sc1
    buffer_load_dwordx4 v[200:203], v1, s[12:15], s50 offen offset:1024 sc1
    buffer_load_dwordx4 v[204:207], v1, s[12:15], s50 offen offset:2048 sc1
    buffer_load_dwordx4 v[208:211], v1, s[12:15], s50 offen offset:3072 sc1
    buffer_load_dwordx4 v[212:215], v2, s[12:15], s50 offen offset:0 sc1
    s_add_u32 s38, s48, 2
    s_and_b32 s38, s38, 7
    s_mul_i32 s38, s38, 20480
    s_add_u32 s50, s36, s38
    buffer_load_dwordx4 v[216:219], v1, s[12:15], s50 offen offset:0 sc1
    buffer_load_dwordx4 v[220:223], v1, s[12:15], s50 offen offset:1024 sc1
    buffer_load_dwordx4 v[224:227], v1, s[12:15], s50 offen offset:2048 sc1
    buffer_load_dwordx4 v[228:231], v1, s[12:15], s50 offen offset:3072 sc1
    buffer_load_dwordx4 v[232:235], v2, s[12:15], s50 offen offset:0 sc1
    s_waitcnt vmcnt(27)
    v_rcp_f32 v9, v108
    s_nop 0
    v_mul_f32 v9, v9, v4
    v_mul_f32 v96, v96, v9
    v_mul_f32 v97, v97, v9
    v_mul_f32 v98, v98, v9
    v_mul_f32 v99, v99, v9
    v_mul_f32 v100, v100, v9
    v_mul_f32 v101, v101, v9
    v_mul_f32 v102, v102, v9
    v_mul_f32 v103, v103, v9
    v_mul_f32 v104, v104, v9
    v_mul_f32 v105, v105, v9
    v_mul_f32 v106, v106, v9
    v_mul_f32 v107, v107, v9
    v_cvt_pk_bf16_f32 v88, v96, v97
    v_cvt_pk_bf16_f32 v89, v98, v99
    v_cvt_pk_bf16_f32 v90, v100, v101
    v_cvt_pk_bf16_f32 v91, v102, v103
    v_cvt_pk_bf16_f32 v92, v104, v105
    v_cvt_pk_bf16_f32 v93, v106, v107
    buffer_store_dwordx4 v[88:91], v8, s[12:15], s41 offen sc1
    s_mov_b32 exec_hi, 0
    buffer_store_dwordx2 v[92:93], v12, s[12:15], s40 offen sc1
    s_mov_b32 exec_hi, -1
    s_setprio 0
    s_lshl_b32 s39, s26, 8
    s_add_u32 s39, s39, 22020096
    v_add_u32 v3, s37, v1
    v_lshlrev_b32 v8, 3, v0
    v_bfe_u32 v96, v5, 2, 8
    buffer_load_dword v96, v96, s[12:15], s39 offen sc1
    v_bfe_u32 v97, v6, 2, 8
    buffer_load_dword v97, v97, s[12:15], s39 offen sc1
    v_bfe_u32 v98, v7, 2, 8
    buffer_load_dword v98, v98, s[12:15], s39 offen sc1
    v_bfe_u32 v99, v11, 2, 8
    buffer_load_dword v99, v99, s[12:15], s39 offen sc1
    s_waitcnt vmcnt(16)
    v_mfma_f32_16x16x32_bf16 v[16:19], v[176:179], v[112:115], 0
    s_add_u32 s38, s48, 3
    s_and_b32 s38, s38, 7
    s_mul_i32 s38, s38, 16384
    s_add_u32 s49, s35, s38
    v_mfma_f32_16x16x32_bf16 v[36:39], v[176:179], v[116:119], 0
    v_mfma_f32_16x16x32_bf16 v[56:59], v[176:179], v[120:123], 0
    buffer_load_dwordx4 v[160:163], v5, s[12:15], s49 offen sc1
    v_mfma_f32_16x16x32_bf16 v[76:79], v[176:179], v[124:127], 0
    v_mfma_f32_16x16x32_bf16 v[20:23], v[180:183], v[112:115], 0
    buffer_load_dwordx4 v[164:167], v6, s[12:15], s49 offen sc1
    v_mfma_f32_16x16x32_bf16 v[40:43], v[180:183], v[116:119], 0
    v_mfma_f32_16x16x32_bf16 v[60:63], v[180:183], v[120:123], 0
    buffer_load_dwordx4 v[168:171], v7, s[12:15], s49 offen sc1
    v_mfma_f32_16x16x32_bf16 v[80:83], v[180:183], v[124:127], 0
    v_mfma_f32_16x16x32_bf16 v[24:27], v[184:187], v[112:115], 0
    buffer_load_dwordx4 v[172:175], v11, s[12:15], s49 offen sc1
    v_mfma_f32_16x16x32_bf16 v[44:47], v[184:187], v[116:119], 0
    v_mfma_f32_16x16x32_bf16 v[64:67], v[184:187], v[120:123], 0
    s_add_u32 s38, s48, 3
    s_and_b32 s38, s38, 7
    s_mul_i32 s38, s38, 20480
    s_add_u32 s50, s36, s38
    v_mfma_f32_16x16x32_bf16 v[84:87], v[184:187], v[124:127], 0
    v_mfma_f32_16x16x32_bf16 v[28:31], v[188:191], v[112:115], 0
    buffer_load_dwordx4 v[236:239], v1, s[12:15], s50 offen offset:0 sc1
    v_mfma_f32_16x16x32_bf16 v[48:51], v[188:191], v[116:119], 0
    v_mfma_f32_16x16x32_bf16 v[68:71], v[188:191], v[120:123], 0
    buffer_load_dwordx4 v[240:243], v1, s[12:15], s50 offen offset:1024 sc1
    v_mfma_f32_16x16x32_bf16 v[88:91], v[188:191], v[124:127], 0
    v_mfma_f32_16x16x32_bf16 v[32:35], v[192:195], v[112:115], 0
    buffer_load_dwordx4 v[244:247], v1, s[12:15], s50 offen offset:2048 sc1
    v_mfma_f32_16x16x32_bf16 v[52:55], v[192:195], v[116:119], 0
    v_mfma_f32_16x16x32_bf16 v[72:75], v[192:195], v[120:123], 0
    buffer_load_dwordx4 v[248:251], v1, s[12:15], s50 offen offset:3072 sc1
    v_mfma_f32_16x16x32_bf16 v[92:95], v[192:195], v[124:127], 0
    buffer_load_dwordx4 v[252:255], v2, s[12:15], s50 offen offset:0 sc1
    s_waitcnt vmcnt(20)
    v_mfma_f32_16x16x32_bf16 v[16:19], v[196:199], v[128:131], v[16:19]
    s_add_u32 s38, s48, 4
    s_and_b32 s38, s38, 7
    s_mul_i32 s38, s38, 16384
    s_add_u32 s49, s35, s38
    v_mfma_f32_16x16x32_bf16 v[36:39], v[196:199], v[132:135], v[36:39]
    v_mfma_f32_16x16x32_bf16 v[56:59], v[196:199], v[136:139], v[56:59]
    buffer_load_dwordx4 v[112:115], v5, s[12:15], s49 offen sc1
    v_mfma_f32_16x16x32_bf16 v[76:79], v[196:199], v[140:143], v[76:79]
    v_mfma_f32_16x16x32_bf16 v[20:23], v[200:203], v[128:131], v[20:23]
    buffer_load_dwordx4 v[116:119], v6, s[12:15], s49 offen sc1
    v_mfma_f32_16x16x32_bf16 v[40:43], v[200:203], v[132:135], v[40:43]
    v_mfma_f32_16x16x32_bf16 v[60:63], v[200:203], v[136:139], v[60:63]
    buffer_load_dwordx4 v[120:123], v7, s[12:15], s49 offen sc1
    v_mfma_f32_16x16x32_bf16 v[80:83], v[200:203], v[140:143], v[80:83]
    v_mfma_f32_16x16x32_bf16 v[24:27], v[204:207], v[128:131], v[24:27]
    buffer_load_dwordx4 v[124:127], v11, s[12:15], s49 offen sc1
    v_mfma_f32_16x16x32_bf16 v[44:47], v[204:207], v[132:135], v[44:47]
    v_mfma_f32_16x16x32_bf16 v[64:67], v[204:207], v[136:139], v[64:67]
    s_add_u32 s38, s48, 4
    s_and_b32 s38, s38, 7
    s_mul_i32 s38, s38, 20480
    s_add_u32 s50, s36, s38
    v_mfma_f32_16x16x32_bf16 v[84:87], v[204:207], v[140:143], v[84:87]
    v_mfma_f32_16x16x32_bf16 v[28:31], v[208:211], v[128:131], v[28:31]
    buffer_load_dwordx4 v[176:179], v1, s[12:15], s50 offen offset:0 sc1
    v_mfma_f32_16x16x32_bf16 v[48:51], v[208:211], v[132:135], v[48:51]
    v_mfma_f32_16x16x32_bf16 v[68:71], v[208:211], v[136:139], v[68:71]
    buffer_load_dwordx4 v[180:183], v1, s[12:15], s50 offen offset:1024 sc1
    v_mfma_f32_16x16x32_bf16 v[88:91], v[208:211], v[140:143], v[88:91]
    v_mfma_f32_16x16x32_bf16 v[32:35], v[212:215], v[128:131], v[32:35]
    buffer_load_dwordx4 v[184:187], v1, s[12:15], s50 offen offset:2048 sc1
    v_mfma_f32_16x16x32_bf16 v[52:55], v[212:215], v[132:135], v[52:55]
    v_mfma_f32_16x16x32_bf16 v[72:75], v[212:215], v[136:139], v[72:75]
    buffer_load_dwordx4 v[188:191], v1, s[12:15], s50 offen offset:3072 sc1
    v_mfma_f32_16x16x32_bf16 v[92:95], v[212:215], v[140:143], v[92:95]
    buffer_load_dwordx4 v[192:195], v2, s[12:15], s50 offen offset:0 sc1
    s_waitcnt vmcnt(24)
    v_mfma_f32_16x16x32_bf16 v[16:19], v[216:219], v[144:147], v[16:19]
    s_add_u32 s38, s48, 5
    s_and_b32 s38, s38, 7
    s_mul_i32 s38, s38, 16384
    s_add_u32 s49, s35, s38
    v_mfma_f32_16x16x32_bf16 v[36:39], v[216:219], v[148:151], v[36:39]
    v_mfma_f32_16x16x32_bf16 v[56:59], v[216:219], v[152:155], v[56:59]
    buffer_load_dwordx4 v[128:131], v5, s[12:15], s49 offen sc1
    v_mfma_f32_16x16x32_bf16 v[76:79], v[216:219], v[156:159], v[76:79]
    v_mfma_f32_16x16x32_bf16 v[20:23], v[220:223], v[144:147], v[20:23]
    buffer_load_dwordx4 v[132:135], v6, s[12:15], s49 offen sc1
    v_mfma_f32_16x16x32_bf16 v[40:43], v[220:223], v[148:151], v[40:43]
    v_mfma_f32_16x16x32_bf16 v[60:63], v[220:223], v[152:155], v[60:63]
    buffer_load_dwordx4 v[136:139], v7, s[12:15], s49 offen sc1
    v_mfma_f32_16x16x32_bf16 v[80:83], v[220:223], v[156:159], v[80:83]
    v_mfma_f32_16x16x32_bf16 v[24:27], v[224:227], v[144:147], v[24:27]
    buffer_load_dwordx4 v[140:143], v11, s[12:15], s49 offen sc1
    v_mfma_f32_16x16x32_bf16 v[44:47], v[224:227], v[148:151], v[44:47]
    v_mfma_f32_16x16x32_bf16 v[64:67], v[224:227], v[152:155], v[64:67]
    s_add_u32 s38, s48, 5
    s_and_b32 s38, s38, 7
    s_mul_i32 s38, s38, 20480
    s_add_u32 s50, s36, s38
    v_mfma_f32_16x16x32_bf16 v[84:87], v[224:227], v[156:159], v[84:87]
    v_mfma_f32_16x16x32_bf16 v[28:31], v[228:231], v[144:147], v[28:31]
    buffer_load_dwordx4 v[196:199], v1, s[12:15], s50 offen offset:0 sc1
    v_mfma_f32_16x16x32_bf16 v[48:51], v[228:231], v[148:151], v[48:51]
    v_mfma_f32_16x16x32_bf16 v[68:71], v[228:231], v[152:155], v[68:71]
    buffer_load_dwordx4 v[200:203], v1, s[12:15], s50 offen offset:1024 sc1
    v_mfma_f32_16x16x32_bf16 v[88:91], v[228:231], v[156:159], v[88:91]
    v_mfma_f32_16x16x32_bf16 v[32:35], v[232:235], v[144:147], v[32:35]
    buffer_load_dwordx4 v[204:207], v1, s[12:15], s50 offen offset:2048 sc1
    v_mfma_f32_16x16x32_bf16 v[52:55], v[232:235], v[148:151], v[52:55]
    v_mfma_f32_16x16x32_bf16 v[72:75], v[232:235], v[152:155], v[72:75]
    buffer_load_dwordx4 v[208:211], v1, s[12:15], s50 offen offset:3072 sc1
    v_mfma_f32_16x16x32_bf16 v[92:95], v[232:235], v[156:159], v[92:95]
    buffer_load_dwordx4 v[212:215], v2, s[12:15], s50 offen offset:0 sc1
    s_waitcnt vmcnt(18)
    v_mov_b32 v12, 1
    s_mov_b64 exec, 1
    buffer_store_dword v12, off, s[12:15], s85 sc1
    s_mov_b64 exec, -1
    v_mfma_f32_16x16x32_bf16 v[16:19], v[236:239], v[160:163], v[16:19]
    s_add_u32 s83, s83, 0x4000
    buffer_load_dword v9, v8, s[12:15], s83 offen sc1
    v_mfma_f32_16x16x32_bf16 v[36:39], v[236:239], v[164:167], v[36:39]
    s_add_u32 s38, s48, 6
    s_and_b32 s38, s38, 7
    s_mul_i32 s38, s38, 16384
    s_add_u32 s49, s35, s38
    v_mfma_f32_16x16x32_bf16 v[56:59], v[236:239], v[168:171], v[56:59]
    buffer_load_dwordx4 v[144:147], v5, s[12:15], s49 offen sc1
    v_mfma_f32_16x16x32_bf16 v[76:79], v[236:239], v[172:175], v[76:79]
    buffer_load_dwordx4 v[148:151], v6, s[12:15], s49 offen sc1
    v_mfma_f32_16x16x32_bf16 v[20:23], v[240:243], v[160:163], v[20:23]
    buffer_load_dwordx4 v[152:155], v7, s[12:15], s49 offen sc1
    v_mfma_f32_16x16x32_bf16 v[40:43], v[240:243], v[164:167], v[40:43]
    buffer_load_dwordx4 v[156:159], v11, s[12:15], s49 offen sc1
    v_mfma_f32_16x16x32_bf16 v[60:63], v[240:243], v[168:171], v[60:63]
    s_add_u32 s38, s48, 6
    s_and_b32 s38, s38, 7
    s_mul_i32 s38, s38, 20480
    s_add_u32 s50, s36, s38
    v_mfma_f32_16x16x32_bf16 v[80:83], v[240:243], v[172:175], v[80:83]
    buffer_load_dwordx4 v[216:219], v1, s[12:15], s50 offen offset:0 sc1
    v_mfma_f32_16x16x32_bf16 v[24:27], v[244:247], v[160:163], v[24:27]
    buffer_load_dwordx4 v[220:223], v1, s[12:15], s50 offen offset:1024 sc1
    v_mfma_f32_16x16x32_bf16 v[44:47], v[244:247], v[164:167], v[44:47]
    buffer_load_dwordx4 v[224:227], v1, s[12:15], s50 offen offset:2048 sc1
    v_mfma_f32_16x16x32_bf16 v[64:67], v[244:247], v[168:171], v[64:67]
    buffer_load_dwordx4 v[228:231], v1, s[12:15], s50 offen offset:3072 sc1
    s_branch PN5
.p2align 12
PG5:
    s_branch WARMED
PN5:
    v_mfma_f32_16x16x32_bf16 v[84:87], v[244:247], v[172:175], v[84:87]
    buffer_load_dwordx4 v[232:235], v2, s[12:15], s50 offen offset:0 sc1
    v_mfma_f32_16x16x32_bf16 v[28:31], v[248:251], v[160:163], v[28:31]
    v_mfma_f32_16x16x32_bf16 v[48:51], v[248:251], v[164:167], v[48:51]
    v_mfma_f32_16x16x32_bf16 v[68:71], v[248:251], v[168:171], v[68:71]
    v_mfma_f32_16x16x32_bf16 v[88:91], v[248:251], v[172:175], v[88:91]
    v_mfma_f32_16x16x32_bf16 v[32:35], v[252:255], v[160:163], v[32:35]
    v_mfma_f32_16x16x32_bf16 v[52:55], v[252:255], v[164:167], v[52:55]
    v_mfma_f32_16x16x32_bf16 v[72:75], v[252:255], v[168:171], v[72:75]
    v_mfma_f32_16x16x32_bf16 v[92:95], v[252:255], v[172:175], v[92:95]
    s_waitcnt vmcnt(19)
    v_mfma_f32_16x16x32_bf16 v[16:19], v[176:179], v[112:115], v[16:19]
    s_add_u32 s38, s48, 7
    s_and_b32 s38, s38, 7
    s_mul_i32 s38, s38, 16384
    s_add_u32 s49, s35, s38
    v_mfma_f32_16x16x32_bf16 v[36:39], v[176:179], v[116:119], v[36:39]
    v_mfma_f32_16x16x32_bf16 v[56:59], v[176:179], v[120:123], v[56:59]
    buffer_load_dwordx4 v[160:163], v5, s[12:15], s49 offen sc1
    v_mfma_f32_16x16x32_bf16 v[76:79], v[176:179], v[124:127], v[76:79]
    v_mfma_f32_16x16x32_bf16 v[20:23], v[180:183], v[112:115], v[20:23]
    buffer_load_dwordx4 v[164:167], v6, s[12:15], s49 offen sc1
    v_mfma_f32_16x16x32_bf16 v[40:43], v[180:183], v[116:119], v[40:43]
    v_mfma_f32_16x16x32_bf16 v[60:63], v[180:183], v[120:123], v[60:63]
    buffer_load_dwordx4 v[168:171], v7, s[12:15], s49 offen sc1
    v_mfma_f32_16x16x32_bf16 v[80:83], v[180:183], v[124:127], v[80:83]
    v_mfma_f32_16x16x32_bf16 v[24:27], v[184:187], v[112:115], v[24:27]
    buffer_load_dwordx4 v[172:175], v11, s[12:15], s49 offen sc1
    v_mfma_f32_16x16x32_bf16 v[44:47], v[184:187], v[116:119], v[44:47]
    v_mfma_f32_16x16x32_bf16 v[64:67], v[184:187], v[120:123], v[64:67]
    s_add_u32 s38, s48, 7
    s_and_b32 s38, s38, 7
    s_mul_i32 s38, s38, 20480
    s_add_u32 s50, s36, s38
    v_mfma_f32_16x16x32_bf16 v[84:87], v[184:187], v[124:127], v[84:87]
    v_mfma_f32_16x16x32_bf16 v[28:31], v[188:191], v[112:115], v[28:31]
    buffer_load_dwordx4 v[236:239], v1, s[12:15], s50 offen offset:0 sc1
    v_mfma_f32_16x16x32_bf16 v[48:51], v[188:191], v[116:119], v[48:51]
    v_mfma_f32_16x16x32_bf16 v[68:71], v[188:191], v[120:123], v[68:71]
    buffer_load_dwordx4 v[240:243], v1, s[12:15], s50 offen offset:1024 sc1
    v_mfma_f32_16x16x32_bf16 v[88:91], v[188:191], v[124:127], v[88:91]
    v_mfma_f32_16x16x32_bf16 v[32:35], v[192:195], v[112:115], v[32:35]
    buffer_load_dwordx4 v[244:247], v1, s[12:15], s50 offen offset:2048 sc1
    v_mfma_f32_16x16x32_bf16 v[52:55], v[192:195], v[116:119], v[52:55]
    v_mfma_f32_16x16x32_bf16 v[72:75], v[192:195], v[120:123], v[72:75]
    buffer_load_dwordx4 v[248:251], v1, s[12:15], s50 offen offset:3072 sc1
    v_mfma_f32_16x16x32_bf16 v[92:95], v[192:195], v[124:127], v[92:95]
    buffer_load_dwordx4 v[252:255], v2, s[12:15], s50 offen offset:0 sc1
    s_waitcnt vmcnt(18)
    s_mov_b32 s88, 0
SPIN5:
    v_cmp_gt_u32 vcc, 1, v9
    s_add_u32 s88, s88, 1
    s_nop 0
    s_and_b64 vcc, vcc, -1
    s_cbranch_scc0 GO5
    s_cmp_gt_u32 s88, 0x20000
    s_cbranch_scc1 GO5
    s_sleep 8
    buffer_load_dword v9, v8, s[12:15], s83 offen sc1
    s_waitcnt vmcnt(0)
    s_branch SPIN5
GO5:
    v_mfma_f32_16x16x32_bf16 v[16:19], v[196:199], v[128:131], v[16:19]
    s_mov_b32 s38, 131072
    s_add_u32 s49, s35, s38
    v_mfma_f32_16x16x32_bf16 v[36:39], v[196:199], v[132:135], v[36:39]
    v_mfma_f32_16x16x32_bf16 v[56:59], v[196:199], v[136:139], v[56:59]
    buffer_load_dwordx4 v[112:115], v5, s[12:15], s49 offen sc1
    v_mfma_f32_16x16x32_bf16 v[76:79], v[196:199], v[140:143], v[76:79]
    v_mfma_f32_16x16x32_bf16 v[20:23], v[200:203], v[128:131], v[20:23]
    buffer_load_dwordx4 v[116:119], v6, s[12:15], s49 offen sc1
    v_mfma_f32_16x16x32_bf16 v[40:43], v[200:203], v[132:135], v[40:43]
    v_mfma_f32_16x16x32_bf16 v[60:63], v[200:203], v[136:139], v[60:63]
    buffer_load_dwordx4 v[120:123], v7, s[12:15], s49 offen sc1
    v_mfma_f32_16x16x32_bf16 v[80:83], v[200:203], v[140:143], v[80:83]
    v_mfma_f32_16x16x32_bf16 v[24:27], v[204:207], v[128:131], v[24:27]
    buffer_load_dwordx4 v[124:127], v11, s[12:15], s49 offen sc1
    v_mfma_f32_16x16x32_bf16 v[44:47], v[204:207], v[132:135], v[44:47]
    v_mfma_f32_16x16x32_bf16 v[64:67], v[204:207], v[136:139], v[64:67]
    s_mov_b32 s38, 163840
    s_add_u32 s50, s36, s38
    v_mfma_f32_16x16x32_bf16 v[84:87], v[204:207], v[140:143], v[84:87]
    v_mfma_f32_16x16x32_bf16 v[28:31], v[208:211], v[128:131], v[28:31]
    buffer_load_dwordx4 v[176:179], v1, s[12:15], s50 offen offset:0 sc1
    v_mfma_f32_16x16x32_bf16 v[48:51], v[208:211], v[132:135], v[48:51]
    v_mfma_f32_16x16x32_bf16 v[68:71], v[208:211], v[136:139], v[68:71]
    buffer_load_dwordx4 v[180:183], v1, s[12:15], s50 offen offset:1024 sc1
    v_mfma_f32_16x16x32_bf16 v[88:91], v[208:211], v[140:143], v[88:91]
    v_mfma_f32_16x16x32_bf16 v[32:35], v[212:215], v[128:131], v[32:35]
    buffer_load_dwordx4 v[184:187], v1, s[12:15], s50 offen offset:2048 sc1
    v_mfma_f32_16x16x32_bf16 v[52:55], v[212:215], v[132:135], v[52:55]
    v_mfma_f32_16x16x32_bf16 v[72:75], v[212:215], v[136:139], v[72:75]
    buffer_load_dwordx4 v[188:191], v1, s[12:15], s50 offen offset:3072 sc1
    v_mfma_f32_16x16x32_bf16 v[92:95], v[212:215], v[140:143], v[92:95]
    buffer_load_dwordx4 v[192:195], v2, s[12:15], s50 offen offset:0 sc1
    s_waitcnt vmcnt(18)
    v_mfma_f32_16x16x32_bf16 v[16:19], v[216:219], v[144:147], v[16:19]
    s_mov_b32 s38, 147456
    s_add_u32 s49, s35, s38
    v_mfma_f32_16x16x32_bf16 v[36:39], v[216:219], v[148:151], v[36:39]
    v_mfma_f32_16x16x32_bf16 v[56:59], v[216:219], v[152:155], v[56:59]
    buffer_load_dwordx4 v[128:131], v5, s[12:15], s49 offen sc1
    v_mfma_f32_16x16x32_bf16 v[76:79], v[216:219], v[156:159], v[76:79]
    v_mfma_f32_16x16x32_bf16 v[20:23], v[220:223], v[144:147], v[20:23]
    buffer_load_dwordx4 v[132:135], v6, s[12:15], s49 offen sc1
    v_mfma_f32_16x16x32_bf16 v[40:43], v[220:223], v[148:151], v[40:43]
    v_mfma_f32_16x16x32_bf16 v[60:63], v[220:223], v[152:155], v[60:63]
    buffer_load_dwordx4 v[136:139], v7, s[12:15], s49 offen sc1
    v_mfma_f32_16x16x32_bf16 v[80:83], v[220:223], v[156:159], v[80:83]
    v_mfma_f32_16x16x32_bf16 v[24:27], v[224:227], v[144:147], v[24:27]
    buffer_load_dwordx4 v[140:143], v11, s[12:15], s49 offen sc1
    v_mfma_f32_16x16x32_bf16 v[44:47], v[224:227], v[148:151], v[44:47]
    v_mfma_f32_16x16x32_bf16 v[64:67], v[224:227], v[152:155], v[64:67]
    s_mov_b32 s38, 184320
    s_add_u32 s50, s36, s38
    v_mfma_f32_16x16x32_bf16 v[84:87], v[224:227], v[156:159], v[84:87]
    v_mfma_f32_16x16x32_bf16 v[28:31], v[228:231], v[144:147], v[28:31]
    buffer_load_dwordx4 v[196:199], v1, s[12:15], s50 offen offset:0 sc1
    v_mfma_f32_16x16x32_bf16 v[48:51], v[228:231], v[148:151], v[48:51]
    v_mfma_f32_16x16x32_bf16 v[68:71], v[228:231], v[152:155], v[68:71]
    buffer_load_dwordx4 v[200:203], v1, s[12:15], s50 offen offset:1024 sc1
    v_mfma_f32_16x16x32_bf16 v[88:91], v[228:231], v[156:159], v[88:91]
    v_mfma_f32_16x16x32_bf16 v[32:35], v[232:235], v[144:147], v[32:35]
    buffer_load_dwordx4 v[204:207], v1, s[12:15], s50 offen offset:2048 sc1
    v_mfma_f32_16x16x32_bf16 v[52:55], v[232:235], v[148:151], v[52:55]
    v_mfma_f32_16x16x32_bf16 v[72:75], v[232:235], v[152:155], v[72:75]
    buffer_load_dwordx4 v[208:211], v1, s[12:15], s50 offen offset:3072 sc1
    v_mfma_f32_16x16x32_bf16 v[92:95], v[232:235], v[156:159], v[92:95]
    buffer_load_dwordx4 v[212:215], v2, s[12:15], s50 offen offset:0 sc1
    s_waitcnt vmcnt(18)
    v_mfma_f32_16x16x32_bf16 v[16:19], v[236:239], v[160:163], v[16:19]
    s_add_u32 s83, s83, 0x4000
    buffer_load_dword v9, v8, s[12:15], s83 offen sc1
    v_mfma_f32_16x16x32_bf16 v[36:39], v[236:239], v[164:167], v[36:39]
    s_mov_b32 s38, 163840
    s_add_u32 s49, s35, s38
    v_mfma_f32_16x16x32_bf16 v[56:59], v[236:239], v[168:171], v[56:59]
    buffer_load_dwordx4 v[144:147], v5, s[12:15], s49 offen sc1
    v_mfma_f32_16x16x32_bf16 v[76:79], v[236:239], v[172:175], v[76:79]
    buffer_load_dwordx4 v[148:151], v6, s[12:15], s49 offen sc1
    v_mfma_f32_16x16x32_bf16 v[20:23], v[240:243], v[160:163], v[20:23]
    buffer_load_dwordx4 v[152:155], v7, s[12:15], s49 offen sc1
    v_mfma_f32_16x16x32_bf16 v[40:43], v[240:243], v[164:167], v[40:43]
    buffer_load_dwordx4 v[156:159], v11, s[12:15], s49 offen sc1
    v_mfma_f32_16x16x32_bf16 v[60:63], v[240:243], v[168:171], v[60:63]
    s_mov_b32 s38, 204800
    s_add_u32 s50, s36, s38
    v_mfma_f32_16x16x32_bf16 v[80:83], v[240:243], v[172:175], v[80:83]
    buffer_load_dwordx4 v[216:219], v1, s[12:15], s50 offen offset:0 sc1
    v_mfma_f32_16x16x32_bf16 v[24:27], v[244:247], v[160:163], v[24:27]
    buffer_load_dwordx4 v[220:223], v1, s[12:15], s50 offen offset:1024 sc1
    v_mfma_f32_16x16x32_bf16 v[44:47], v[244:247], v[164:167], v[44:47]
    buffer_load_dwordx4 v[224:227], v1, s[12:15], s50 offen offset:2048 sc1
    v_mfma_f32_16x16x32_bf16 v[64:67], v[244:247], v[168:171], v[64:67]
    buffer_load_dwordx4 v[228:231], v1, s[12:15], s50 offen offset:3072 sc1
    v_mfma_f32_16x16x32_bf16 v[84:87], v[244:247], v[172:175], v[84:87]
    buffer_load_dwordx4 v[232:235], v2, s[12:15], s50 offen offset:0 sc1
    v_mfma_f32_16x16x32_bf16 v[28:31], v[248:251], v[160:163], v[28:31]
    v_mfma_f32_16x16x32_bf16 v[48:51], v[248:251], v[164:167], v[48:51]
    v_mfma_f32_16x16x32_bf16 v[68:71], v[248:251], v[168:171], v[68:71]
    v_mfma_f32_16x16x32_bf16 v[88:91], v[248:251], v[172:175], v[88:91]
    v_mfma_f32_16x16x32_bf16 v[32:35], v[252:255], v[160:163], v[32:35]
    v_mfma_f32_16x16x32_bf16 v[52:55], v[252:255], v[164:167], v[52:55]
    v_mfma_f32_16x16x32_bf16 v[72:75], v[252:255], v[168:171], v[72:75]
    v_mfma_f32_16x16x32_bf16 v[92:95], v[252:255], v[172:175], v[92:95]
    s_waitcnt vmcnt(19)
    v_mfma_f32_16x16x32_bf16 v[16:19], v[176:179], v[112:115], v[16:19]
    s_mov_b32 s38, 180224
    s_add_u32 s49, s35, s38
    v_mfma_f32_16x16x32_bf16 v[36:39], v[176:179], v[116:119], v[36:39]
    v_mfma_f32_16x16x32_bf16 v[56:59], v[176:179], v[120:123], v[56:59]
    buffer_load_dwordx4 v[160:163], v5, s[12:15], s49 offen sc1
    v_mfma_f32_16x16x32_bf16 v[76:79], v[176:179], v[124:127], v[76:79]
    v_mfma_f32_16x16x32_bf16 v[20:23], v[180:183], v[112:115], v[20:23]
    buffer_load_dwordx4 v[164:167], v6, s[12:15], s49 offen sc1
    v_mfma_f32_16x16x32_bf16 v[40:43], v[180:183], v[116:119], v[40:43]
    v_mfma_f32_16x16x32_bf16 v[60:63], v[180:183], v[120:123], v[60:63]
    buffer_load_dwordx4 v[168:171], v7, s[12:15], s49 offen sc1
    v_mfma_f32_16x16x32_bf16 v[80:83], v[180:183], v[124:127], v[80:83]
    v_mfma_f32_16x16x32_bf16 v[24:27], v[184:187], v[112:115], v[24:27]
    buffer_load_dwordx4 v[172:175], v11, s[12:15], s49 offen sc1
    v_mfma_f32_16x16x32_bf16 v[44:47], v[184:187], v[116:119], v[44:47]
    v_mfma_f32_16x16x32_bf16 v[64:67], v[184:187], v[120:123], v[64:67]
    s_mov_b32 s38, 225280
    s_add_u32 s50, s36, s38
    v_mfma_f32_16x16x32_bf16 v[84:87], v[184:187], v[124:127], v[84:87]
    v_mfma_f32_16x16x32_bf16 v[28:31], v[188:191], v[112:115], v[28:31]
    buffer_load_dwordx4 v[236:239], v1, s[12:15], s50 offen offset:0 sc1
    v_mfma_f32_16x16x32_bf16 v[48:51], v[188:191], v[116:119], v[48:51]
    v_mfma_f32_16x16x32_bf16 v[68:71], v[188:191], v[120:123], v[68:71]
    buffer_load_dwordx4 v[240:243], v1, s[12:15], s50 offen offset:1024 sc1
    v_mfma_f32_16x16x32_bf16 v[88:91], v[188:191], v[124:127], v[88:91]
    v_mfma_f32_16x16x32_bf16 v[32:35], v[192:195], v[112:115], v[32:35]
    buffer_load_dwordx4 v[244:247], v1, s[12:15], s50 offen offset:2048 sc1
    v_mfma_f32_16x16x32_bf16 v[52:55], v[192:195], v[116:119], v[52:55]
    v_mfma_f32_16x16x32_bf16 v[72:75], v[192:195], v[120:123], v[72:75]
    buffer_load_dwordx4 v[248:251], v1, s[12:15], s50 offen offset:3072 sc1
    v_mfma_f32_16x16x32_bf16 v[92:95], v[192:195], v[124:127], v[92:95]
    buffer_load_dwordx4 v[252:255], v2, s[12:15], s50 offen offset:0 sc1
    s_waitcnt vmcnt(18)
    s_mov_b32 s88, 0
SPIN6:
    v_cmp_gt_u32 vcc, 1, v9
    s_add_u32 s88, s88, 1
    s_nop 0
    s_and_b64 vcc, vcc, -1
    s_cbranch_scc0 GO6
    s_cmp_gt_u32 s88, 0x20000
    s_cbranch_scc1 GO6
    s_sleep 8
    buffer_load_dword v9, v8, s[12:15], s83 offen sc1
    s_waitcnt vmcnt(0)
    s_branch SPIN6
GO6:
    v_mfma_f32_16x16x32_bf16 v[16:19], v[196:199], v[128:131], v[16:19]
    s_mov_b32 s38, 196608
    s_add_u32 s49, s35, s38
    v_mfma_f32_16x16x32_bf16 v[36:39], v[196:199], v[132:135], v[36:39]
    v_mfma_f32_16x16x32_bf16 v[56:59], v[196:199], v[136:139], v[56:59]
    buffer_load_dwordx4 v[112:115], v5, s[12:15], s49 offen sc1
    v_mfma_f32_16x16x32_bf16 v[76:79], v[196:199], v[140:143], v[76:79]
    v_mfma_f32_16x16x32_bf16 v[20:23], v[200:203], v[128:131], v[20:23]
    buffer_load_dwordx4 v[116:119], v6, s[12:15], s49 offen sc1
    v_mfma_f32_16x16x32_bf16 v[40:43], v[200:203], v[132:135], v[40:43]
    v_mfma_f32_16x16x32_bf16 v[60:63], v[200:203], v[136:139], v[60:63]
    buffer_load_dwordx4 v[120:123], v7, s[12:15], s49 offen sc1
    v_mfma_f32_16x16x32_bf16 v[80:83], v[200:203], v[140:143], v[80:83]
    v_mfma_f32_16x16x32_bf16 v[24:27], v[204:207], v[128:131], v[24:27]
    buffer_load_dwordx4 v[124:127], v11, s[12:15], s49 offen sc1
    v_mfma_f32_16x16x32_bf16 v[44:47], v[204:207], v[132:135], v[44:47]
    v_mfma_f32_16x16x32_bf16 v[64:67], v[204:207], v[136:139], v[64:67]
    v_mfma_f32_16x16x32_bf16 v[84:87], v[204:207], v[140:143], v[84:87]
    v_mfma_f32_16x16x32_bf16 v[28:31], v[208:211], v[128:131], v[28:31]
    v_mfma_f32_16x16x32_bf16 v[48:51], v[208:211], v[132:135], v[48:51]
    v_mfma_f32_16x16x32_bf16 v[68:71], v[208:211], v[136:139], v[68:71]
    v_mfma_f32_16x16x32_bf16 v[88:91], v[208:211], v[140:143], v[88:91]
    v_mfma_f32_16x16x32_bf16 v[32:35], v[212:215], v[128:131], v[32:35]
    v_mfma_f32_16x16x32_bf16 v[52:55], v[212:215], v[132:135], v[52:55]
    v_mfma_f32_16x16x32_bf16 v[72:75], v[212:215], v[136:139], v[72:75]
    v_mfma_f32_16x16x32_bf16 v[92:95], v[212:215], v[140:143], v[92:95]
    s_waitcnt vmcnt(13)
    v_mfma_f32_16x16x32_bf16 v[16:19], v[216:219], v[144:147], v[16:19]
    s_mov_b32 s38, 212992
    s_add_u32 s49, s35, s38
    v_mfma_f32_16x16x32_bf16 v[36:39], v[216:219], v[148:151], v[36:39]
    v_mfma_f32_16x16x32_bf16 v[56:59], v[216:219], v[152:155], v[56:59]
    buffer_load_dwordx4 v[128:131], v5, s[12:15], s49 offen sc1
    v_mfma_f32_16x16x32_bf16 v[76:79], v[216:219], v[156:159], v[76:79]
    v_mfma_f32_16x16x32_bf16 v[20:23], v[220:223], v[144:147], v[20:23]
    buffer_load_dwordx4 v[132:135], v6, s[12:15], s49 offen sc1
    v_mfma_f32_16x16x32_bf16 v[40:43], v[220:223], v[148:151], v[40:43]
    v_mfma_f32_16x16x32_bf16 v[60:63], v[220:223], v[152:155], v[60:63]
    buffer_load_dwordx4 v[136:139], v7, s[12:15], s49 offen sc1
    v_mfma_f32_16x16x32_bf16 v[80:83], v[220:223], v[156:159], v[80:83]
    v_mfma_f32_16x16x32_bf16 v[24:27], v[224:227], v[144:147], v[24:27]
    buffer_load_dwordx4 v[140:143], v11, s[12:15], s49 offen sc1
    v_mfma_f32_16x16x32_bf16 v[44:47], v[224:227], v[148:151], v[44:47]
    v_mfma_f32_16x16x32_bf16 v[64:67], v[224:227], v[152:155], v[64:67]
    v_mfma_f32_16x16x32_bf16 v[84:87], v[224:227], v[156:159], v[84:87]
    v_mfma_f32_16x16x32_bf16 v[28:31], v[228:231], v[144:147], v[28:31]
    v_mfma_f32_16x16x32_bf16 v[48:51], v[228:231], v[148:151], v[48:51]
    v_mfma_f32_16x16x32_bf16 v[68:71], v[228:231], v[152:155], v[68:71]
    v_mfma_f32_16x16x32_bf16 v[88:91], v[228:231], v[156:159], v[88:91]
    v_mfma_f32_16x16x32_bf16 v[32:35], v[232:235], v[144:147], v[32:35]
    v_mfma_f32_16x16x32_bf16 v[52:55], v[232:235], v[148:151], v[52:55]
    v_mfma_f32_16x16x32_bf16 v[72:75], v[232:235], v[152:155], v[72:75]
    v_mfma_f32_16x16x32_bf16 v[92:95], v[232:235], v[156:159], v[92:95]
    s_waitcnt vmcnt(8)
    s_lshl_b32 s38, s30, 2
    v_mov_b32 v10, s38
    ds_read_b32 v9, v10 offset:45440
    s_waitcnt lgkmcnt(0)
    s_mov_b32 s88, 0
SPIN7:
    v_cmp_gt_u32 vcc, 1, v9
    s_add_u32 s88, s88, 1
    s_nop 0
    s_and_b64 vcc, vcc, -1
    s_cbranch_scc0 GO7
    s_cmp_gt_u32 s88, 0x20000
    s_cbranch_scc1 GO7
    s_sleep 2
    ds_read_b32 v9, v10 offset:45440
    s_waitcnt lgkmcnt(0)
    s_branch SPIN7
GO7:
    v_mfma_f32_16x16x32_bf16 v[16:19], v[236:239], v[160:163], v[16:19]
    ds_read_b128 v[176:179], v3 offset:0
    v_mfma_f32_16x16x32_bf16 v[36:39], v[236:239], v[164:167], v[36:39]
    v_mfma_f32_16x16x32_bf16 v[56:59], v[236:239], v[168:171], v[56:59]
    ds_read_b128 v[180:183], v3 offset:1024
    v_mfma_f32_16x16x32_bf16 v[76:79], v[236:239], v[172:175], v[76:79]
    v_mfma_f32_16x16x32_bf16 v[20:23], v[240:243], v[160:163], v[20:23]
    ds_read_b128 v[184:187], v3 offset:2048
    v_mfma_f32_16x16x32_bf16 v[40:43], v[240:243], v[164:167], v[40:43]
    v_mfma_f32_16x16x32_bf16 v[60:63], v[240:243], v[168:171], v[60:63]
    ds_read_b128 v[188:191], v3 offset:3072
    v_mfma_f32_16x16x32_bf16 v[80:83], v[240:243], v[172:175], v[80:83]
    v_mfma_f32_16x16x32_bf16 v[24:27], v[244:247], v[160:163], v[24:27]
    ds_read_b128 v[192:195], v3 offset:4096
    v_mfma_f32_16x16x32_bf16 v[44:47], v[244:247], v[164:167], v[44:47]
    v_mfma_f32_16x16x32_bf16 v[64:67], v[244:247], v[168:171], v[64:67]
    s_mov_b32 s38, 229376
    s_add_u32 s49, s35, s38
    v_mfma_f32_16x16x32_bf16 v[84:87], v[244:247], v[172:175], v[84:87]
    v_mfma_f32_16x16x32_bf16 v[28:31], v[248:251], v[160:163], v[28:31]
    buffer_load_dwordx4 v[144:147], v5, s[12:15], s49 offen sc1
    v_mfma_f32_16x16x32_bf16 v[48:51], v[248:251], v[164:167], v[48:51]
    v_mfma_f32_16x16x32_bf16 v[68:71], v[248:251], v[168:171], v[68:71]
    buffer_load_dwordx4 v[148:151], v6, s[12:15], s49 offen sc1
    v_mfma_f32_16x16x32_bf16 v[88:91], v[248:251], v[172:175], v[88:91]
    v_mfma_f32_16x16x32_bf16 v[32:35], v[252:255], v[160:163], v[32:35]
    buffer_load_dwordx4 v[152:155], v7, s[12:15], s49 offen sc1
    v_mfma_f32_16x16x32_bf16 v[52:55], v[252:255], v[164:167], v[52:55]
    v_mfma_f32_16x16x32_bf16 v[72:75], v[252:255], v[168:171], v[72:75]
    buffer_load_dwordx4 v[156:159], v11, s[12:15], s49 offen sc1
    v_mfma_f32_16x16x32_bf16 v[92:95], v[252:255], v[172:175], v[92:95]
    v_sub_f32 v96, 1.0, v96
    v_sub_f32 v97, 1.0, v97
    v_sub_f32 v98, 1.0, v98
    v_sub_f32 v99, 1.0, v99
    v_pk_mul_f32 v[16:17], v[16:17], v[96:97] op_sel:[0,0] op_sel_hi:[1,0]
    v_pk_mul_f32 v[18:19], v[18:19], v[96:97] op_sel:[0,0] op_sel_hi:[1,0]
    v_pk_mul_f32 v[36:37], v[36:37], v[96:97] op_sel:[0,1] op_sel_hi:[1,1]
    v_pk_mul_f32 v[38:39], v[38:39], v[96:97] op_sel:[0,1] op_sel_hi:[1,1]
    v_pk_mul_f32 v[56:57], v[56:57], v[98:99] op_sel:[0,0] op_sel_hi:[1,0]
    v_pk_mul_f32 v[58:59], v[58:59], v[98:99] op_sel:[0,0] op_sel_hi:[1,0]
    v_pk_mul_f32 v[76:77], v[76:77], v[98:99] op_sel:[0,1] op_sel_hi:[1,1]
    v_pk_mul_f32 v[78:79], v[78:79], v[98:99] op_sel:[0,1] op_sel_hi:[1,1]
    v_pk_mul_f32 v[20:21], v[20:21], v[96:97] op_sel:[0,0] op_sel_hi:[1,0]
    v_pk_mul_f32 v[22:23], v[22:23], v[96:97] op_sel:[0,0] op_sel_hi:[1,0]
    v_pk_mul_f32 v[40:41], v[40:41], v[96:97] op_sel:[0,1] op_sel_hi:[1,1]
    v_pk_mul_f32 v[42:43], v[42:43], v[96:97] op_sel:[0,1] op_sel_hi:[1,1]
    v_pk_mul_f32 v[60:61], v[60:61], v[98:99] op_sel:[0,0] op_sel_hi:[1,0]
    v_pk_mul_f32 v[62:63], v[62:63], v[98:99] op_sel:[0,0] op_sel_hi:[1,0]
    v_pk_mul_f32 v[80:81], v[80:81], v[98:99] op_sel:[0,1] op_sel_hi:[1,1]
    v_pk_mul_f32 v[82:83], v[82:83], v[98:99] op_sel:[0,1] op_sel_hi:[1,1]
    v_pk_mul_f32 v[24:25], v[24:25], v[96:97] op_sel:[0,0] op_sel_hi:[1,0]
    v_pk_mul_f32 v[26:27], v[26:27], v[96:97] op_sel:[0,0] op_sel_hi:[1,0]
    v_pk_mul_f32 v[44:45], v[44:45], v[96:97] op_sel:[0,1] op_sel_hi:[1,1]
    v_pk_mul_f32 v[46:47], v[46:47], v[96:97] op_sel:[0,1] op_sel_hi:[1,1]
    v_pk_mul_f32 v[64:65], v[64:65], v[98:99] op_sel:[0,0] op_sel_hi:[1,0]
    v_pk_mul_f32 v[66:67], v[66:67], v[98:99] op_sel:[0,0] op_sel_hi:[1,0]
    v_pk_mul_f32 v[84:85], v[84:85], v[98:99] op_sel:[0,1] op_sel_hi:[1,1]
    v_pk_mul_f32 v[86:87], v[86:87], v[98:99] op_sel:[0,1] op_sel_hi:[1,1]
    v_pk_mul_f32 v[28:29], v[28:29], v[96:97] op_sel:[0,0] op_sel_hi:[1,0]
    v_pk_mul_f32 v[30:31], v[30:31], v[96:97] op_sel:[0,0] op_sel_hi:[1,0]
    v_pk_mul_f32 v[48:49], v[48:49], v[96:97] op_sel:[0,1] op_sel_hi:[1,1]
    v_pk_mul_f32 v[50:51], v[50:51], v[96:97] op_sel:[0,1] op_sel_hi:[1,1]
    v_pk_mul_f32 v[68:69], v[68:69], v[98:99] op_sel:[0,0] op_sel_hi:[1,0]
    v_pk_mul_f32 v[70:71], v[70:71], v[98:99] op_sel:[0,0] op_sel_hi:[1,0]
    v_pk_mul_f32 v[88:89], v[88:89], v[98:99] op_sel:[0,1] op_sel_hi:[1,1]
    v_pk_mul_f32 v[90:91], v[90:91], v[98:99] op_sel:[0,1] op_sel_hi:[1,1]
    v_pk_mul_f32 v[32:33], v[32:33], v[96:97] op_sel:[0,0] op_sel_hi:[1,0]
    v_pk_mul_f32 v[34:35], v[34:35], v[96:97] op_sel:[0,0] op_sel_hi:[1,0]
    v_pk_mul_f32 v[52:53], v[52:53], v[96:97] op_sel:[0,1] op_sel_hi:[1,1]
    v_pk_mul_f32 v[54:55], v[54:55], v[96:97] op_sel:[0,1] op_sel_hi:[1,1]
    v_pk_mul_f32 v[72:73], v[72:73], v[98:99] op_sel:[0,0] op_sel_hi:[1,0]
    v_pk_mul_f32 v[74:75], v[74:75], v[98:99] op_sel:[0,0] op_sel_hi:[1,0]
    v_pk_mul_f32 v[92:93], v[92:93], v[98:99] op_sel:[0,1] op_sel_hi:[1,1]
    v_pk_mul_f32 v[94:95], v[94:95], v[98:99] op_sel:[0,1] op_sel_hi:[1,1]
    s_waitcnt vmcnt(8) lgkmcnt(0)
    v_mfma_f32_16x16x32_bf16 v[16:19], v[176:179], v[112:115], v[16:19]
    ds_read_b128 v[196:199], v3 offset:5120
    v_mfma_f32_16x16x32_bf16 v[36:39], v[176:179], v[116:119], v[36:39]
    v_mfma_f32_16x16x32_bf16 v[56:59], v[176:179], v[120:123], v[56:59]
    ds_read_b128 v[200:203], v3 offset:6144
    v_mfma_f32_16x16x32_bf16 v[76:79], v[176:179], v[124:127], v[76:79]
    v_mfma_f32_16x16x32_bf16 v[20:23], v[180:183], v[112:115], v[20:23]
    ds_read_b128 v[204:207], v3 offset:7168
    v_mfma_f32_16x16x32_bf16 v[40:43], v[180:183], v[116:119], v[40:43]
    v_mfma_f32_16x16x32_bf16 v[60:63], v[180:183], v[120:123], v[60:63]
    ds_read_b128 v[208:211], v3 offset:8192
    v_mfma_f32_16x16x32_bf16 v[80:83], v[180:183], v[124:127], v[80:83]
    v_mfma_f32_16x16x32_bf16 v[24:27], v[184:187], v[112:115], v[24:27]
    ds_read_b128 v[212:215], v3 offset:9216
    v_mfma_f32_16x16x32_bf16 v[44:47], v[184:187], v[116:119], v[44:47]
    v_mfma_f32_16x16x32_bf16 v[64:67], v[184:187], v[120:123], v[64:67]
    s_mov_b32 s38, 245760
    s_add_u32 s49, s35, s38
    v_mfma_f32_16x16x32_bf16 v[84:87], v[184:187], v[124:127], v[84:87]
    v_mfma_f32_16x16x32_bf16 v[28:31], v[188:191], v[112:115], v[28:31]
    buffer_load_dwordx4 v[160:163], v5, s[12:15], s49 offen sc1
    v_mfma_f32_16x16x32_bf16 v[48:51], v[188:191], v[116:119], v[48:51]
    v_mfma_f32_16x16x32_bf16 v[68:71], v[188:191], v[120:123], v[68:71]
    buffer_load_dwordx4 v[164:167], v6, s[12:15], s49 offen sc1
    v_mfma_f32_16x16x32_bf16 v[88:91], v[188:191], v[124:127], v[88:91]
    v_mfma_f32_16x16x32_bf16 v[32:35], v[192:195], v[112:115], v[32:35]
    buffer_load_dwordx4 v[168:171], v7, s[12:15], s49 offen sc1
    v_mfma_f32_16x16x32_bf16 v[52:55], v[192:195], v[116:119], v[52:55]
    v_mfma_f32_16x16x32_bf16 v[72:75], v[192:195], v[120:123], v[72:75]
    buffer_load_dwordx4 v[172:175], v11, s[12:15], s49 offen sc1
    v_mfma_f32_16x16x32_bf16 v[92:95], v[192:195], v[124:127], v[92:95]
    s_waitcnt vmcnt(8) lgkmcnt(0)
    v_mfma_f32_16x16x32_bf16 v[16:19], v[196:199], v[128:131], v[16:19]
    ds_read_b128 v[216:219], v3 offset:10240
    v_mfma_f32_16x16x32_bf16 v[36:39], v[196:199], v[132:135], v[36:39]
    v_mfma_f32_16x16x32_bf16 v[56:59], v[196:199], v[136:139], v[56:59]
    ds_read_b128 v[220:223], v3 offset:11264
    v_mfma_f32_16x16x32_bf16 v[76:79], v[196:199], v[140:143], v[76:79]
    v_mfma_f32_16x16x32_bf16 v[20:23], v[200:203], v[128:131], v[20:23]
    ds_read_b128 v[224:227], v3 offset:12288
    v_mfma_f32_16x16x32_bf16 v[40:43], v[200:203], v[132:135], v[40:43]
    v_mfma_f32_16x16x32_bf16 v[60:63], v[200:203], v[136:139], v[60:63]
    ds_read_b128 v[228:231], v3 offset:13312
    v_mfma_f32_16x16x32_bf16 v[80:83], v[200:203], v[140:143], v[80:83]
    v_mfma_f32_16x16x32_bf16 v[24:27], v[204:207], v[128:131], v[24:27]
    ds_read_b128 v[232:235], v3 offset:14336
    v_mfma_f32_16x16x32_bf16 v[44:47], v[204:207], v[132:135], v[44:47]
    v_mfma_f32_16x16x32_bf16 v[64:67], v[204:207], v[136:139], v[64:67]
    s_mov_b32 s38, 262144
    s_add_u32 s49, s35, s38
    v_mfma_f32_16x16x32_bf16 v[84:87], v[204:207], v[140:143], v[84:87]
    v_mfma_f32_16x16x32_bf16 v[28:31], v[208:211], v[128:131], v[28:31]
    v_and_b32 v12, 0x3ff, v5
    v_lshrrev_b32 v12, 1, v12
    v_lshl_add_u32 v12, v14, 10, v12
    buffer_load_dwordx2 v[112:113], v12, s[12:15], s49 offen offset:0 sc1
    buffer_load_dwordx2 v[114:115], v12, s[12:15], s49 offen offset:512 sc1
    v_mfma_f32_16x16x32_bf16 v[48:51], v[208:211], v[132:135], v[48:51]
    v_mfma_f32_16x16x32_bf16 v[68:71], v[208:211], v[136:139], v[68:71]
    v_and_b32 v12, 0x3ff, v6
    v_lshrrev_b32 v12, 1, v12
    v_lshl_add_u32 v12, v14, 10, v12
    buffer_load_dwordx2 v[116:117], v12, s[12:15], s49 offen offset:0 sc1
    buffer_load_dwordx2 v[118:119], v12, s[12:15], s49 offen offset:512 sc1
    v_mfma_f32_16x16x32_bf16 v[88:91], v[208:211], v[140:143], v[88:91]
    v_mfma_f32_16x16x32_bf16 v[32:35], v[212:215], v[128:131], v[32:35]
    v_and_b32 v12, 0x3ff, v7
    v_lshrrev_b32 v12, 1, v12
    v_lshl_add_u32 v12, v14, 10, v12
    buffer_load_dwordx2 v[120:121], v12, s[12:15], s49 offen offset:0 sc1
    buffer_load_dwordx2 v[122:123], v12, s[12:15], s49 offen offset:512 sc1
    v_mfma_f32_16x16x32_bf16 v[52:55], v[212:215], v[132:135], v[52:55]
    v_mfma_f32_16x16x32_bf16 v[72:75], v[212:215], v[136:139], v[72:75]
    v_and_b32 v12, 0x3ff, v11
    v_lshrrev_b32 v12, 1, v12
    v_lshl_add_u32 v12, v14, 10, v12
    buffer_load_dwordx2 v[124:125], v12, s[12:15], s49 offen offset:0 sc1
    buffer_load_dwordx2 v[126:127], v12, s[12:15], s49 offen offset:512 sc1
    v_mfma_f32_16x16x32_bf16 v[92:95], v[212:215], v[140:143], v[92:95]
    s_waitcnt vmcnt(12) lgkmcnt(0)
    v_mfma_f32_16x16x32_bf16 v[16:19], v[216:219], v[144:147], v[16:19]
    ds_read_b128 v[236:239], v3 offset:15360
    v_mfma_f32_16x16x32_bf16 v[36:39], v[216:219], v[148:151], v[36:39]
    v_mfma_f32_16x16x32_bf16 v[56:59], v[216:219], v[152:155], v[56:59]
    ds_read_b128 v[240:243], v3 offset:16384
    v_mfma_f32_16x16x32_bf16 v[76:79], v[216:219], v[156:159], v[76:79]
    v_mfma_f32_16x16x32_bf16 v[20:23], v[220:223], v[144:147], v[20:23]
    ds_read_b128 v[244:247], v3 offset:17408
    v_mfma_f32_16x16x32_bf16 v[40:43], v[220:223], v[148:151], v[40:43]
    v_mfma_f32_16x16x32_bf16 v[60:63], v[220:223], v[152:155], v[60:63]
    ds_read_b128 v[248:251], v3 offset:18432
    v_mfma_f32_16x16x32_bf16 v[80:83], v[220:223], v[156:159], v[80:83]
    v_mfma_f32_16x16x32_bf16 v[24:27], v[224:227], v[144:147], v[24:27]
    ds_read_b128 v[252:255], v3 offset:19456
    v_mfma_f32_16x16x32_bf16 v[44:47], v[224:227], v[148:151], v[44:47]
    v_mfma_f32_16x16x32_bf16 v[64:67], v[224:227], v[152:155], v[64:67]
    v_mfma_f32_16x16x32_bf16 v[84:87], v[224:227], v[156:159], v[84:87]
    v_mfma_f32_16x16x32_bf16 v[28:31], v[228:231], v[144:147], v[28:31]
    v_mfma_f32_16x16x32_bf16 v[48:51], v[228:231], v[148:151], v[48:51]
    v_mfma_f32_16x16x32_bf16 v[68:71], v[228:231], v[152:155], v[68:71]
    v_mfma_f32_16x16x32_bf16 v[88:91], v[228:231], v[156:159], v[88:91]
    v_mfma_f32_16x16x32_bf16 v[32:35], v[232:235], v[144:147], v[32:35]
    v_mfma_f32_16x16x32_bf16 v[52:55], v[232:235], v[148:151], v[52:55]
    v_mfma_f32_16x16x32_bf16 v[72:75], v[232:235], v[152:155], v[72:75]
    v_mfma_f32_16x16x32_bf16 v[92:95], v[232:235], v[156:159], v[92:95]
    s_waitcnt vmcnt(8) lgkmcnt(0)
    v_mfma_f32_16x16x32_bf16 v[16:19], v[236:239], v[160:163], v[16:19]
    ds_read_b128 v[176:179], v3 offset:20480
    v_mfma_f32_16x16x32_bf16 v[36:39], v[236:239], v[164:167], v[36:39]
    v_mfma_f32_16x16x32_bf16 v[56:59], v[236:239], v[168:171], v[56:59]
    ds_read_b128 v[180:183], v3 offset:21504
    v_mfma_f32_16x16x32_bf16 v[76:79], v[236:239], v[172:175], v[76:79]
    v_mfma_f32_16x16x32_bf16 v[20:23], v[240:243], v[160:163], v[20:23]
    ds_read_b128 v[184:187], v3 offset:22528
    v_mfma_f32_16x16x32_bf16 v[40:43], v[240:243], v[164:167], v[40:43]
    v_mfma_f32_16x16x32_bf16 v[60:63], v[240:243], v[168:171], v[60:63]
    ds_read_b128 v[188:191], v3 offset:23552
    v_mfma_f32_16x16x32_bf16 v[80:83], v[240:243], v[172:175], v[80:83]
    v_mfma_f32_16x16x32_bf16 v[24:27], v[244:247], v[160:163], v[24:27]
    ds_read_b128 v[192:195], v3 offset:24576
    v_mfma_f32_16x16x32_bf16 v[44:47], v[244:247], v[164:167], v[44:47]
    v_mfma_f32_16x16x32_bf16 v[64:67], v[244:247], v[168:171], v[64:67]
    s_mul_i32 s38, s45, 25600
    s_add_u32 s38, s38, 71680
    v_add_u32 v5, s38, v1
    s_mul_i32 s38, s46, 25600
    s_add_u32 s38, s38, 66560
    v_add_u32 v6, s38, v1
    s_mul_i32 s38, s47, 25600
    s_add_u32 s38, s38, 61440
    v_add_u32 v7, s38, v1
    s_lshl_b32 s38, s26, 6
    s_lshl_b32 s39, s30, 4
    s_add_u32 s38, s38, s39
    s_mul_i32 s38, s38, 1280
    s_mul_i32 s39, s27, 160
    s_add_u32 s38, s38, s39
    s_and_b32 s52, s27, 1
    s_lshl_b32 s39, s52, 7
    s_sub_u32 s39, s38, s39
    s_lshl_b32 s52, s52, 5
    s_add_u32 s38, s38, s52
    v_mul_u32_u24 v11, 1280, v13
    v_and_b32 v12, 1, v14
    v_lshl_add_u32 v12, v12, 5, v11
    v_lshrrev_b32 v9, 1, v14
    v_lshl_add_u32 v12, v9, 4, v12
    v_lshl_add_u32 v11, v14, 3, v11
    v_mfma_f32_16x16x32_bf16 v[84:87], v[244:247], v[172:175], v[84:87]
    v_mfma_f32_16x16x32_bf16 v[28:31], v[248:251], v[160:163], v[28:31]
    v_mfma_f32_16x16x32_bf16 v[48:51], v[248:251], v[164:167], v[48:51]
    v_mfma_f32_16x16x32_bf16 v[68:71], v[248:251], v[168:171], v[68:71]
    v_mfma_f32_16x16x32_bf16 v[88:91], v[248:251], v[172:175], v[88:91]
    v_mfma_f32_16x16x32_bf16 v[32:35], v[252:255], v[160:163], v[32:35]
    v_mfma_f32_16x16x32_bf16 v[52:55], v[252:255], v[164:167], v[52:55]
    v_mfma_f32_16x16x32_bf16 v[72:75], v[252:255], v[168:171], v[72:75]
    v_mfma_f32_16x16x32_bf16 v[92:95], v[252:255], v[172:175], v[92:95]
    s_waitcnt vmcnt(0) lgkmcnt(0)
    v_mfma_f32_16x16x32_bf16 v[36:39], v[176:179], v[116:119], v[36:39]
    v_mfma_f32_16x16x32_bf16 v[40:43], v[180:183], v[116:119], v[40:43]
    v_mfma_f32_16x16x32_bf16 v[44:47], v[184:187], v[116:119], v[44:47]
    v_mfma_f32_16x16x32_bf16 v[48:51], v[188:191], v[116:119], v[48:51]
    v_mfma_f32_16x16x32_bf16 v[52:55], v[192:195], v[116:119], v[52:55]
    v_mfma_f32_16x16x32_bf16 v[56:59], v[176:179], v[120:123], v[56:59]
    s_nop 2
    ds_write_b128 v3, v[36:39] offset:0
    v_mfma_f32_16x16x32_bf16 v[60:63], v[180:183], v[120:123], v[60:63]
    ds_write_b128 v3, v[40:43] offset:1024
    v_mfma_f32_16x16x32_bf16 v[64:67], v[184:187], v[120:123], v[64:67]
    ds_write_b128 v3, v[44:47] offset:2048
    v_mfma_f32_16x16x32_bf16 v[68:71], v[188:191], v[120:123], v[68:71]
    ds_write_b128 v3, v[48:51] offset:3072
    v_mfma_f32_16x16x32_bf16 v[72:75], v[192:195], v[120:123], v[72:75]
    ds_write_b128 v3, v[52:55] offset:4096
    v_mfma_f32_16x16x32_bf16 v[76:79], v[176:179], v[124:127], v[76:79]
    ds_write_b128 v3, v[56:59] offset:5120
    v_mfma_f32_16x16x32_bf16 v[80:83], v[180:183], v[124:127], v[80:83]
    ds_write_b128 v3, v[60:63] offset:6144
    v_mfma_f32_16x16x32_bf16 v[84:87], v[184:187], v[124:127], v[84:87]
    ds_write_b128 v3, v[64:67] offset:7168
    v_mfma_f32_16x16x32_bf16 v[88:91], v[188:191], v[124:127], v[88:91]
    ds_write_b128 v3, v[68:71] offset:8192
    v_mfma_f32_16x16x32_bf16 v[92:95], v[192:195], v[124:127], v[92:95]
    ds_write_b128 v3, v[72:75] offset:9216
    v_mfma_f32_16x16x32_bf16 v[16:19], v[176:179], v[112:115], v[16:19]
    ds_write_b128 v3, v[76:79] offset:10240
    v_mfma_f32_16x16x32_bf16 v[20:23], v[180:183], v[112:115], v[20:23]
    ds_write_b128 v3, v[80:83] offset:11264
    v_mfma_f32_16x16x32_bf16 v[24:27], v[184:187], v[112:115], v[24:27]
    ds_write_b128 v3, v[84:87] offset:12288
    v_mfma_f32_16x16x32_bf16 v[28:31], v[188:191], v[112:115], v[28:31]
    ds_write_b128 v3, v[88:91] offset:13312
    v_mfma_f32_16x16x32_bf16 v[32:35], v[192:195], v[112:115], v[32:35]
    ds_write_b128 v3, v[92:95] offset:14336
    s_waitcnt lgkmcnt(0)
    s_barrier
    ds_read_b128 v[112:115], v5 offset:0
    ds_read_b128 v[116:119], v6 offset:0
    ds_read_b128 v[120:123], v7 offset:0
    s_branch PN6
.p2align 12
PG6:
    s_branch WARMED
PN6:
    ds_read_b128 v[124:127], v5 offset:1024
    ds_read_b128 v[128:131], v6 offset:1024
    ds_read_b128 v[132:135], v7 offset:1024
    ds_read_b128 v[136:139], v5 offset:2048
    ds_read_b128 v[140:143], v6 offset:2048
    ds_read_b128 v[144:147], v7 offset:2048
    ds_read_b128 v[148:151], v5 offset:3072
    ds_read_b128 v[152:155], v6 offset:3072
    ds_read_b128 v[156:159], v7 offset:3072
    ds_read_b128 v[160:163], v5 offset:4096
    ds_read_b128 v[164:167], v6 offset:4096
    ds_read_b128 v[168:171], v7 offset:4096
    s_waitcnt lgkmcnt(12)
    v_pk_add_f32 v[16:17], v[16:17], v[112:113]
    v_pk_add_f32 v[116:117], v[116:117], v[120:121]
    v_pk_add_f32 v[18:19], v[18:19], v[114:115]
    v_pk_add_f32 v[118:119], v[118:119], v[122:123]
    v_pk_add_f32 v[16:17], v[16:17], v[116:117]
    v_pk_add_f32 v[18:19], v[18:19], v[118:119]
    v_cvt_pk_bf16_f32 v96, v16, v17
    v_cvt_pk_bf16_f32 v97, v18, v19
    s_waitcnt lgkmcnt(9)
    v_pk_add_f32 v[20:21], v[20:21], v[124:125]
    v_pk_add_f32 v[128:129], v[128:129], v[132:133]
    v_pk_add_f32 v[22:23], v[22:23], v[126:127]
    v_pk_add_f32 v[130:131], v[130:131], v[134:135]
    v_pk_add_f32 v[20:21], v[20:21], v[128:129]
    v_pk_add_f32 v[22:23], v[22:23], v[130:131]
    v_cvt_pk_bf16_f32 v98, v20, v21
    v_cvt_pk_bf16_f32 v99, v22, v23
    s_nop 0
    v_permlane16_swap_b32 v96, v98
    v_permlane16_swap_b32 v97, v99
    buffer_store_dwordx4 v[96:99], v12, s[8:11], s38 offen offset:0 sc1
    s_waitcnt lgkmcnt(6)
    v_pk_add_f32 v[24:25], v[24:25], v[136:137]
    v_pk_add_f32 v[140:141], v[140:141], v[144:145]
    v_pk_add_f32 v[26:27], v[26:27], v[138:139]
    v_pk_add_f32 v[142:143], v[142:143], v[146:147]
    v_pk_add_f32 v[24:25], v[24:25], v[140:141]
    v_pk_add_f32 v[26:27], v[26:27], v[142:143]
    v_cvt_pk_bf16_f32 v100, v24, v25
    v_cvt_pk_bf16_f32 v101, v26, v27
    s_waitcnt lgkmcnt(3)
    v_pk_add_f32 v[28:29], v[28:29], v[148:149]
    v_pk_add_f32 v[152:153], v[152:153], v[156:157]
    v_pk_add_f32 v[30:31], v[30:31], v[150:151]
    v_pk_add_f32 v[154:155], v[154:155], v[158:159]
    v_pk_add_f32 v[28:29], v[28:29], v[152:153]
    v_pk_add_f32 v[30:31], v[30:31], v[154:155]
    v_cvt_pk_bf16_f32 v102, v28, v29
    v_cvt_pk_bf16_f32 v103, v30, v31
    s_nop 0
    v_permlane16_swap_b32 v100, v102
    v_permlane16_swap_b32 v101, v103
    buffer_store_dwordx4 v[100:103], v12, s[8:11], s38 offen offset:64 sc1
    s_waitcnt lgkmcnt(0)
    v_pk_add_f32 v[32:33], v[32:33], v[160:161]
    v_pk_add_f32 v[164:165], v[164:165], v[168:169]
    v_pk_add_f32 v[34:35], v[34:35], v[162:163]
    v_pk_add_f32 v[166:167], v[166:167], v[170:171]
    v_pk_add_f32 v[32:33], v[32:33], v[164:165]
    v_pk_add_f32 v[34:35], v[34:35], v[166:167]
    v_cvt_pk_bf16_f32 v104, v32, v33
    v_cvt_pk_bf16_f32 v105, v34, v35
    buffer_store_dwordx2 v[104:105], v11, s[8:11], s39 offen offset:128 sc1
END:
    s_endpgm
GATE:
    s_nop 7
    v_permlane32_swap_b32 v49, v50
    v_permlane32_swap_b32 v53, v54
    v_add_f32 v48, v48, v50
    v_add_f32 v49, v52, v54
    v_mul_f32 v48, 0xbfb8aa3b, v48
    v_mul_f32 v49, 0xbfb8aa3b, v49
    v_exp_f32 v48, v48
    v_exp_f32 v49, v49
    v_lshlrev_b32 v50, 3, v0
    v_add_f32 v48, 1.0, v48
    v_add_f32 v49, 1.0, v49
    v_rcp_f32 v48, v48
    v_rcp_f32 v49, v49
    s_mov_b64 exec, 0xffff
    buffer_store_dwordx2 v[48:49], v50, s[12:15], s79 offen sc1
    s_mov_b64 exec, -1
    s_branch GATED
FIXB0:
    s_nop 11
    v_mov_b32 v112, v9
    v_mov_b32 v113, v9
    v_mov_b32 v114, v9
    v_mov_b32 v115, v9
    v_mov_b32 v116, v9
    v_mov_b32 v117, v9
    v_mov_b32 v118, v9
    v_mov_b32 v119, v9
    v_mov_b32 v120, v9
    v_mov_b32 v121, v9
    v_mov_b32 v122, v9
    v_mov_b32 v123, v9
    v_mov_b32 v124, v9
    v_mov_b32 v125, v9
    v_mov_b32 v126, v9
    v_mov_b32 v127, v9
    s_branch NOFIXB0
FIXB1:
    s_nop 11
    v_mov_b32 v128, v9
    v_mov_b32 v129, v9
    v_mov_b32 v130, v9
    v_mov_b32 v131, v9
    v_mov_b32 v132, v9
    v_mov_b32 v133, v9
    v_mov_b32 v134, v9
    v_mov_b32 v135, v9
    v_mov_b32 v136, v9
    v_mov_b32 v137, v9
    v_mov_b32 v138, v9
    v_mov_b32 v139, v9
    v_mov_b32 v140, v9
    v_mov_b32 v141, v9
    v_mov_b32 v142, v9
    v_mov_b32 v143, v9
    s_branch NOFIXB1
FIXB2:
    s_nop 11
    v_mov_b32 v144, v9
    v_mov_b32 v145, v9
    v_mov_b32 v146, v9
    v_mov_b32 v147, v9
    v_mov_b32 v148, v9
    v_mov_b32 v149, v9
    v_mov_b32 v150, v9
    v_mov_b32 v151, v9
    v_mov_b32 v152, v9
    v_mov_b32 v153, v9
    v_mov_b32 v154, v9
    v_mov_b32 v155, v9
    v_mov_b32 v156, v9
    v_mov_b32 v157, v9
    v_mov_b32 v158, v9
    v_mov_b32 v159, v9
    s_branch NOFIXB2
FIXB3:
    s_nop 11
    v_mov_b32 v160, v9
    v_mov_b32 v161, v9
    v_mov_b32 v162, v9
    v_mov_b32 v163, v9
    v_mov_b32 v164, v9
    v_mov_b32 v165, v9
    v_mov_b32 v166, v9
    v_mov_b32 v167, v9
    v_mov_b32 v168, v9
    v_mov_b32 v169, v9
    v_mov_b32 v170, v9
    v_mov_b32 v171, v9
    v_mov_b32 v172, v9
    v_mov_b32 v173, v9
    v_mov_b32 v174, v9
    v_mov_b32 v175, v9
    s_branch NOFIXB3
FIXB4:
    s_nop 11
    v_mov_b32 v176, v9
    v_mov_b32 v177, v9
    v_mov_b32 v178, v9
    v_mov_b32 v179, v9
    v_mov_b32 v180, v9
    v_mov_b32 v181, v9
    v_mov_b32 v182, v9
    v_mov_b32 v183, v9
    v_mov_b32 v184, v9
    v_mov_b32 v185, v9
    v_mov_b32 v186, v9
    v_mov_b32 v187, v9
    v_mov_b32 v188, v9
    v_mov_b32 v189, v9
    v_mov_b32 v190, v9
    v_mov_b32 v191, v9
    s_branch NOFIXB4
FIXB5:
    s_nop 11
    v_mov_b32 v192, v9
    v_mov_b32 v193, v9
    v_mov_b32 v194, v9
    v_mov_b32 v195, v9
    v_mov_b32 v196, v9
    v_mov_b32 v197, v9
    v_mov_b32 v198, v9
    v_mov_b32 v199, v9
    v_mov_b32 v200, v9
    v_mov_b32 v201, v9
    v_mov_b32 v202, v9
    v_mov_b32 v203, v9
    v_mov_b32 v204, v9
    v_mov_b32 v205, v9
    v_mov_b32 v206, v9
    v_mov_b32 v207, v9
    s_branch NOFIXB5
FIXB6:
    s_nop 11
    v_mov_b32 v208, v9
    v_mov_b32 v209, v9
    v_mov_b32 v210, v9
    v_mov_b32 v211, v9
    v_mov_b32 v212, v9
    v_mov_b32 v213, v9
    v_mov_b32 v214, v9
    v_mov_b32 v215, v9
    v_mov_b32 v216, v9
    v_mov_b32 v217, v9
    v_mov_b32 v218, v9
    v_mov_b32 v219, v9
    v_mov_b32 v220, v9
    v_mov_b32 v221, v9
    v_mov_b32 v222, v9
    v_mov_b32 v223, v9
    s_branch NOFIXB6
FIXB7:
    s_nop 11
    v_mov_b32 v224, v9
    v_mov_b32 v225, v9
    v_mov_b32 v226, v9
    v_mov_b32 v227, v9
    v_mov_b32 v228, v9
    v_mov_b32 v229, v9
    v_mov_b32 v230, v9
    v_mov_b32 v231, v9
    v_mov_b32 v232, v9
    v_mov_b32 v233, v9
    v_mov_b32 v234, v9
    v_mov_b32 v235, v9
    v_mov_b32 v236, v9
    v_mov_b32 v237, v9
    v_mov_b32 v238, v9
    v_mov_b32 v239, v9
    s_branch NOFIXB7
FIXA0:
    s_nop 11
    v_mov_b32 v112, v9
    v_mov_b32 v113, v9
    v_mov_b32 v114, v9
    v_mov_b32 v115, v9
    v_mov_b32 v116, v9
    v_mov_b32 v117, v9
    v_mov_b32 v118, v9
    v_mov_b32 v119, v9
    v_mov_b32 v120, v9
    v_mov_b32 v121, v9
    v_mov_b32 v122, v9
    v_mov_b32 v123, v9
    v_mov_b32 v124, v9
    v_mov_b32 v125, v9
    v_mov_b32 v126, v9
    v_mov_b32 v127, v9
    s_branch NOFIXA0
FIXA1:
    s_nop 11
    v_mov_b32 v128, v9
    v_mov_b32 v129, v9
    v_mov_b32 v130, v9
    v_mov_b32 v131, v9
    v_mov_b32 v132, v9
    v_mov_b32 v133, v9
    v_mov_b32 v134, v9
    v_mov_b32 v135, v9
    v_mov_b32 v136, v9
    v_mov_b32 v137, v9
    v_mov_b32 v138, v9
    v_mov_b32 v139, v9
    v_mov_b32 v140, v9
    v_mov_b32 v141, v9
    v_mov_b32 v142, v9
    v_mov_b32 v143, v9
    s_branch NOFIXA1
FIXA2:
    s_nop 11
    v_mov_b32 v144, v9
    v_mov_b32 v145, v9
    v_mov_b32 v146, v9
    v_mov_b32 v147, v9
    v_mov_b32 v148, v9
    v_mov_b32 v149, v9
    v_mov_b32 v150, v9
    v_mov_b32 v151, v9
    v_mov_b32 v152, v9
    v_mov_b32 v153, v9
    v_mov_b32 v154, v9
    v_mov_b32 v155, v9
    v_mov_b32 v156, v9
    v_mov_b32 v157, v9
    v_mov_b32 v158, v9
    v_mov_b32 v159, v9
    s_branch NOFIXA2
FIXA3:
    s_nop 11
    v_mov_b32 v160, v9
    v_mov_b32 v161, v9
    v_mov_b32 v162, v9
    v_mov_b32 v163, v9
    v_mov_b32 v164, v9
    v_mov_b32 v165, v9
    v_mov_b32 v166, v9
    v_mov_b32 v167, v9
    v_mov_b32 v168, v9
    v_mov_b32 v169, v9
    v_mov_b32 v170, v9
    v_mov_b32 v171, v9
    v_mov_b32 v172, v9
    v_mov_b32 v173, v9
    v_mov_b32 v174, v9
    v_mov_b32 v175, v9
    s_branch NOFIXA3
FIXA4:
    s_nop 11
    v_mov_b32 v176, v9
    v_mov_b32 v177, v9
    v_mov_b32 v178, v9
    v_mov_b32 v179, v9
    v_mov_b32 v180, v9
    v_mov_b32 v181, v9
    v_mov_b32 v182, v9
    v_mov_b32 v183, v9
    v_mov_b32 v184, v9
    v_mov_b32 v185, v9
    v_mov_b32 v186, v9
    v_mov_b32 v187, v9
    v_mov_b32 v188, v9
    v_mov_b32 v189, v9
    v_mov_b32 v190, v9
    v_mov_b32 v191, v9
    s_branch NOFIXA4
FIXA5:
    s_nop 11
    v_mov_b32 v192, v9
    v_mov_b32 v193, v9
    v_mov_b32 v194, v9
    v_mov_b32 v195, v9
    v_mov_b32 v196, v9
    v_mov_b32 v197, v9
    v_mov_b32 v198, v9
    v_mov_b32 v199, v9
    v_mov_b32 v200, v9
    v_mov_b32 v201, v9
    v_mov_b32 v202, v9
    v_mov_b32 v203, v9
    v_mov_b32 v204, v9
    v_mov_b32 v205, v9
    v_mov_b32 v206, v9
    v_mov_b32 v207, v9
    s_branch NOFIXA5
FIXA6:
    s_nop 11
    v_mov_b32 v208, v9
    v_mov_b32 v209, v9
    v_mov_b32 v210, v9
    v_mov_b32 v211, v9
    v_mov_b32 v212, v9
    v_mov_b32 v213, v9
    v_mov_b32 v214, v9
    v_mov_b32 v215, v9
    v_mov_b32 v216, v9
    v_mov_b32 v217, v9
    v_mov_b32 v218, v9
    v_mov_b32 v219, v9
    v_mov_b32 v220, v9
    v_mov_b32 v221, v9
    v_mov_b32 v222, v9
    v_mov_b32 v223, v9
    s_branch NOFIXA6
FIXA7:
    s_nop 11
    v_mov_b32 v224, v9
    v_mov_b32 v225, v9
    v_mov_b32 v226, v9
    v_mov_b32 v227, v9
    v_mov_b32 v228, v9
    v_mov_b32 v229, v9
    v_mov_b32 v230, v9
    v_mov_b32 v231, v9
    v_mov_b32 v232, v9
    v_mov_b32 v233, v9
    v_mov_b32 v234, v9
    v_mov_b32 v235, v9
    v_mov_b32 v236, v9
    v_mov_b32 v237, v9
    v_mov_b32 v238, v9
    v_mov_b32 v239, v9
    s_branch NOFIXA7
PG7:
    s_branch WARMED
.section .rodata,"a"
.p2align 6
.amdhsa_kernel gated_mix__sliding_block__swiglu_ffn__prompt_kernel
  .amdhsa_next_free_vgpr 256
  .amdhsa_next_free_sgpr 102
  .amdhsa_accum_offset 256
  .amdhsa_group_segment_fixed_size 0
  .amdhsa_kernarg_size 88
  .amdhsa_user_sgpr_count 2
  .amdhsa_user_sgpr_kernarg_segment_ptr 1
  .amdhsa_system_sgpr_workgroup_id_x 1
.end_amdhsa_kernel
```
